```python
import torch

def _softmax(x, axis=-1):
    return torch.softmax(x, dim=axis)
def _gelu(x):
    return torch.nn.functional.gelu(x, approximate="tanh")
def _silu(x):
    return torch.nn.functional.silu(x)
def _sigmoid(x):
    return torch.sigmoid(x)
def _layernorm(x, axis=-1, eps=1e-5):
    m = x.mean(dim=axis, keepdim=True)
    v = x.var(dim=axis, keepdim=True, unbiased=False)
    return (x - m) / torch.sqrt(v + eps)
def _scatter_add(tgt, idx, src, axis=0):
    return tgt.clone().index_add_(axis, idx, src)
def _segment_sum(src, seg, n):
    out = torch.zeros((n,) + src.shape[1:], dtype=src.dtype)
    return out.index_add_(0, seg, src)
def _pad(x, pw):
    flat = tuple(v for pair in reversed(pw) for v in pair)
    return torch.nn.functional.pad(x, flat)

kernel_name = 'interleave_layers__grouped_kv_mqa__ssm_conv_h3__prompt'

def setup_inputs():

    _w = (lambda a: (lambda t: t.to(torch.bfloat16) if t.is_floating_point() else t)(torch.as_tensor(a)))
    def _A_setup():
        B, S, D, H = 1, 2048, 512, 32
        Dh = D // H
        return {
            "x": _w((lambda *s: torch.randn(*s, dtype=torch.bfloat16) * 0.05)(B, S, D)),
            "wq": _w((lambda *s: torch.randn(*s, dtype=torch.bfloat16) * 0.05)(D, H * Dh)),
            "wk": _w((lambda *s: torch.randn(*s, dtype=torch.bfloat16) * 0.05)(D, Dh)),
            "wv": _w((lambda *s: torch.randn(*s, dtype=torch.bfloat16) * 0.05)(D, Dh)),
            "wo": _w((lambda *s: torch.randn(*s, dtype=torch.bfloat16) * 0.05)(H * Dh, D)),
        }
    _A_in = _A_setup()

    def _B_setup():
        B, S, D = 1, 2048, 512
        ks = 4
        return {
            "q": _w((lambda *s: torch.randn(*s, dtype=torch.bfloat16) * 0.05)(B, S, D)),
            "k": _w((lambda *s: torch.randn(*s, dtype=torch.bfloat16) * 0.4)(B, S, D)),
            "v": _w((lambda *s: torch.randn(*s, dtype=torch.bfloat16) * 0.4)(B, S, D)),
            "shift_k": _w((lambda *s: torch.randn(*s, dtype=torch.bfloat16) * 0.4)(D, ks) * 0.5),
            "ssm_k": _w((lambda *s: torch.randn(*s, dtype=torch.bfloat16) * 0.8)(D, S) * (1.0 / S ** 0.5)),
            "ssm_D": _w((lambda *s: torch.randn(*s, dtype=torch.bfloat16) * 0.4)(D)),
        }
    _B_in = _B_setup()

    return {
        "A_x": _A_in["x"],
        "A_wq": _A_in["wq"],
        "A_wk": _A_in["wk"],
        "A_wv": _A_in["wv"],
        "A_wo": _A_in["wo"],
        "B_q": _B_in["q"],
        "B_k": _B_in["k"],
        "B_v": _B_in["v"],
        "B_shift_k": _B_in["shift_k"],
        "B_ssm_k": _B_in["ssm_k"],
        "B_ssm_D": _B_in["ssm_D"],
    }

def reference(A_x, A_wq, A_wk, A_wv, A_wo, B_q, B_k, B_v, B_shift_k, B_ssm_k, B_ssm_D):
    def _A_ref(x, wq, wk, wv, wo):
        B, S, D = x.shape
        H = 32
        Dh = D // H
        q = (lambda x, *d: x.permute(*d))((x @ wq).reshape(B, S, H, Dh), 0, 2, 1, 3)
        k = x @ wk
        v = x @ wv
        scores = torch.einsum("bhqd,bkd->bhqk", q, k) * (Dh ** -0.5)
        p = _softmax(scores, axis=-1)
        o = torch.einsum("bhqk,bkd->bhqd", p, v)
        return (lambda x, *d: x.permute(*d))(o, 0, 2, 1, 3).reshape(B, S, H * Dh) @ wo

    def _B_ref(q, k, v, shift_k, ssm_k, ssm_D):
        B, S, D = q.shape
        ks = shift_k.shape[-1]
        k_pad = _pad(k, ((0, 0), (ks - 1, 0), (0, 0)))
        k_shift = torch.zeros_like(k)
        for t in range(ks):
            k_shift = k_shift + k_pad[:, t:t + S, :] * shift_k[:, ks - 1 - t][None, None, :]
        kv = k_shift * v
        L = 2 * S
        kv_pad = _pad(kv, ((0, 0), (0, S), (0, 0)))
        kf_pad = _pad(ssm_k, ((0, 0), (0, S)))
        kv_f = (lambda x, axes=(-2,-1): torch.fft.rfft2(x.float(), dim=axes))(kv_pad[:, None, :, :], axes=(1, 2))
        kf_f = (lambda x, axes=(-2,-1): torch.fft.rfft2(x.float(), dim=axes))(kf_pad[:, None, :], axes=(1, 2))
        kf_f = (lambda x, *d: x.permute(*d))(kf_f, 1, 2, 0)
        y_f = kv_f * kf_f[None, :, :, :]
        y = (lambda x, s, axes=(-2,-1): torch.fft.irfft2(x, s=s, dim=axes).to(torch.bfloat16))(y_f, (1, L), axes=(1, 2))[:, 0, :S, :]
        y = y + kv * ssm_D[None, None, :]
        return q * y

    x = A_x
    x = x + _A_ref(_layernorm(x, axis=-1), A_wq, A_wk, A_wv, A_wo)
    x = x + _B_ref(_layernorm(x, axis=-1), B_k, B_v, B_shift_k, B_ssm_k, B_ssm_D)
    x = x + _A_ref(_layernorm(x, axis=-1), A_wq, A_wk, A_wv, A_wo)
    x = x + _B_ref(_layernorm(x, axis=-1), B_k, B_v, B_shift_k, B_ssm_k, B_ssm_D)
    return x
```

```asm
; @launch grid=(256,1,1) block=(768,1,1) lds=159744
.amdgcn_target "amdgcn-amd-amdhsa--gfx950"
.text
.globl interleave_layers__grouped_kv_mqa__ssm_conv_h3__prompt_kernel
.p2align 8
.type interleave_layers__grouped_kv_mqa__ssm_conv_h3__prompt_kernel,@function
interleave_layers__grouped_kv_mqa__ssm_conv_h3__prompt_kernel:
    s_cmp_ge_u32 s2, 256
    s_cbranch_scc1 L_exit
    s_setprio 3
    s_load_dwordx16 s[8:23], s[0:1], 0
    s_load_dwordx8 s[24:31], s[0:1], 64
    s_load_dwordx4 s[32:35], s[0:1], 96
    v_cmp_gt_u32 vcc, 20, v0
    s_getpc_b64 s[84:85]
    s_lshr_b32 s6, s2, 3
    s_mul_i32 s6, s6, 1280
    s_cbranch_vccz L_nocp
    v_lshl_add_u32 v2, v0, 6, s6
    v_min_u32 v2, L_exit-interleave_layers__grouped_kv_mqa__ssm_conv_h3__prompt_kernel-64, v2
    s_mov_b64 exec, vcc
    global_load_dword v103, v2, s[84:85]
    s_mov_b64 exec, -1
L_nocp:
    v_lshrrev_b32 v1, 6, v0
    v_and_b32 v0, 63, v0
    v_readfirstlane_b32 s3, v1
    s_and_b32 s6, s2, 7
    s_lshl_b32 s6, s6, 5
    s_lshr_b32 s7, s2, 3
    s_add_u32 s4, s6, s7
    s_mov_b32 s38, 11796480
    s_mov_b32 s39, 0x20000
    v_lshlrev_b32 v4, 4, v0
    s_cmp_ge_u32 s3, 8
    s_waitcnt lgkmcnt(0)
    s_mov_b32 s36, s34
    s_mov_b32 s37, s35
    s_cbranch_scc1 L_helper
    s_mov_b32 s40, s8
    s_mov_b32 s41, s9
    s_mov_b32 s42, 2097152
    s_mov_b32 s43, 0x20000
    s_lshl_b32 s6, s4, 3
    s_add_u32 s6, s6, s3
    s_lshl_b32 s70, s6, 10
    buffer_load_dwordx4 v[16:19], v4, s[40:43], s70 offen
    s_cmp_lg_u32 s3, 1
    s_cbranch_scc1 L_a_noclr
    s_load_dword s5, s[34:35], 0
    v_and_b32 v20, 0x1f0, v4
    v_lshrrev_b32 v21, 5, v0
    v_lshl_add_u32 v20, v21, 17, v20
    v_mov_b64 v[24:25], -1
    v_mov_b64 v[26:27], -1
    s_lshl_b32 s6, s4, 9
    s_add_u32 s6, s6, 65536
    s_lshl_b32 s7, s4, 11
    s_add_u32 s7, s7, 1048576
    buffer_store_dwordx4 v[24:27], v20, s[36:39], s6 offen sc1
    v_and_b32 v20, 0xf0, v4
    v_lshrrev_b32 v21, 4, v0
    v_lshl_add_u32 v20, v21, 10, v20
    s_lshl_b32 s7, s4, 12
    s_add_u32 s7, s7, 6553600
    buffer_store_dwordx4 v[24:27], v20, s[36:39], s7 offen sc1
L_a_noclr:
    s_cmp_lt_u32 s3, 4
    s_cselect_b32 s48, s12, s14
    s_cselect_b32 s49, s13, s15
    s_mov_b32 s50, 0x4000
    s_mov_b32 s51, 0x20000
    s_lshl_b32 s6, s3, 12
    s_add_u32 m0, s6, 45056
    s_and_b32 s6, s6, 0x3000
    s_setprio 2
    buffer_load_dwordx4 v4, s[48:51], s6 offen offset:0 lds
    buffer_load_dwordx4 v4, s[48:51], s6 offen offset:1024 lds
    buffer_load_dwordx4 v4, s[48:51], s6 offen offset:2048 lds
    buffer_load_dwordx4 v4, s[48:51], s6 offen offset:3072 lds
    s_setprio 1
    s_mov_b32 s75, 0
    s_mov_b32 s86, 0x3827c5ac
    s_mov_b32 s87, 0x3827c5ac
    s_mov_b32 s88, 0xffff
    s_mov_b32 s89, 0xffff
    s_cmp_ge_u32 s3, 4
    s_cbranch_scc1 L_a_s0
    s_lshl_b32 s75, s3, 14
    s_add_u32 s75, s75, 45056
    s_cmp_lt_u32 s3, 2
    s_cbranch_scc1 L_a_s0
    s_bfe_u32 s60, s4, 0x20003
    s_lshr_b32 s61, s4, 5
    s_and_b32 s62, s4, 7
    s_lshl_b32 s79, s60, 6
    s_lshl_b32 s6, s61, 3
    s_add_u32 s79, s79, s6
    s_add_u32 s79, s79, s62
    s_lshl_b32 s79, s79, 5
    s_cmp_eq_u32 s3, 2
    s_cselect_b32 s44, s10, s16
    s_cselect_b32 s45, s11, s17
    s_mov_b32 s46, 0x80000
    s_mov_b32 s47, 0x20000
    s_cbranch_scc0 L_a_s3
    v_lshrrev_b32 v40, 1, v0
    v_lshlrev_b32 v40, 10, v40
    v_and_b32 v41, 16, v4
    v_add_u32 v40, v40, v41
    s_lshl_b32 s6, s62, 16
    s_lshr_b32 s7, s4, 3
    s_lshl_b32 s7, s7, 5
    s_add_u32 s6, s6, s7
    s_add_u32 s7, s6, 32768
    s_lshl_b32 s76, s4, 11
    s_add_u32 s76, s76, 1048576
    s_add_u32 s79, s79, 16384
    s_mov_b32 s75, 28672
    s_branch L_a_s4
L_a_s3:
    v_lshrrev_b32 v40, 4, v0
    v_lshlrev_b32 v40, 10, v40
    v_and_b32 v41, 0xf0, v4
    v_add_u32 v40, v40, v41
    s_lshl_b32 s76, s61, 16
    s_lshl_b32 s6, s62, 13
    s_add_u32 s6, s6, s76
    s_lshl_b32 s7, s60, 8
    s_add_u32 s6, s6, s7
    s_lshl_b32 s7, s60, 14
    s_add_u32 s76, s76, s7
    s_lshl_b32 s7, s62, 8
    s_add_u32 s76, s76, s7
    s_add_u32 s7, s6, 4096
    s_add_u32 s76, s76, 1572864
    s_add_u32 s79, s79, 24576
    s_mov_b32 s75, 30720
L_a_s4:
    s_mov_b32 m0, s75
    s_nop 0
    buffer_load_dwordx4 v40, s[44:47], s6 offen lds
    s_add_u32 m0, s75, 1024
    s_nop 0
    buffer_load_dwordx4 v40, s[44:47], s7 offen lds
L_a_s0:
    s_lshl_b32 s6, s4, 9
    s_lshl_b32 s7, s3, 8
    s_add_u32 s58, s6, s7
    s_add_u32 s58, s58, 65536
    s_cmp_eq_u32 s3, 0
    s_cselect_b32 s59, 1052289595, 1.0
    s_cselect_b32 s72, 2, 16
    s_cselect_b32 s73, 32, 4
    s_cselect_b32 s74, 16, 2
    v_mov_b32 v6, 0xdddd
    v_mov_b64 v[2:3], 0
    s_lshl_b32 s6, s3, 11
    s_add_u32 s6, s6, 28672
    v_add_u32 v5, s6, v4
    s_lshr_b32 s6, s3, 2
    s_lshl_b32 s6, s6, 9
    s_and_b32 s7, s3, 3
    s_lshl_b32 s7, s7, 2
    s_add_u32 s6, s6, s7
    v_and_b32 v1, 0x1f0, v4
    v_add_u32 v1, s6, v1
    v_bfe_u32 v20, v0, 1, 2
    v_xor_b32 v7, s3, v20
    v_lshlrev_b32 v7, 5, v7
    v_lshl_add_u32 v7, v20, 8, v7
    v_and_b32 v20, 1, v0
    v_lshl_add_u32 v7, v20, 4, v7
    v_lshrrev_b32 v20, 3, v0
    v_lshl_add_u32 v7, v20, 10, v7
    v_bfe_u32 v20, v0, 3, 2
    v_lshlrev_b32 v21, 9, v20
    v_and_b32 v20, 7, v0
    v_lshl_add_u32 v21, v20, 4, v21
    v_and_b32 v22, 0xf0, v4
    v_bfe_u32 v20, v0, 4, 1
    v_lshl_add_u32 v22, v20, 10, v22
    v_lshrrev_b32 v20, 5, v0
    v_lshl_add_u32 v21, v20, 7, v21
    v_lshl_add_u32 v22, v20, 9, v22
    v_add_u32 v22, 256, v22
    v_and_b32 v20, 11, v0
    v_cmp_eq_u32 vcc, 0, v20
    v_mov_b32 v20, 0x3f803f80
    s_nop 0
    v_cndmask_b32 v108, 0, v20, vcc
    v_mov_b32 v109, v108
    v_mov_b64 v[110:111], v[108:109]
    v_mov_b64 v[116:117], v[108:109]
    v_mov_b64 v[118:119], v[108:109]
    v_mov_b64 v[124:125], v[108:109]
    v_mov_b64 v[126:127], v[108:109]
    v_mov_b64 v[132:133], v[108:109]
    v_mov_b64 v[134:135], v[108:109]
    v_mov_b64 v[140:141], v[108:109]
    v_mov_b64 v[142:143], v[108:109]
    v_mov_b64 v[148:149], v[108:109]
    v_mov_b64 v[150:151], v[108:109]
    v_mov_b64 v[156:157], v[108:109]
    v_mov_b64 v[158:159], v[108:109]
    v_mov_b64 v[164:165], v[108:109]
    v_mov_b64 v[166:167], v[108:109]
    s_mov_b32 s57, 20000
    v_lshrrev_b32 v20, 4, v0
    v_lshlrev_b32 v20, 5, v20
    v_xor_b32 v20, v20, v4
    v_lshrrev_b32 v120, 5, v0
    v_lshlrev_b32 v120, 4, v120
    v_bfe_u32 v121, v0, 4, 1
    v_lshl_add_u32 v120, v121, 2, v120
    v_bfe_u32 v121, v0, 3, 1
    v_lshl_add_u32 v120, v121, 3, v120
    v_bfe_u32 v121, v0, 2, 1
    v_add_u32 v120, v120, v121
    v_and_b32 v121, 3, v0
    v_lshlrev_b32 v121, 3, v121
    v_lshl_add_u32 v120, v120, 5, v121
    v_add_u32 v120, s75, v120
    s_and_b32 s6, s4, 3
    s_xor_b32 s6, s6, s3
    s_lshr_b32 s7, s4, 5
    s_add_u32 s6, s6, s7
    s_add_u32 s6, s6, 1
    s_lshr_b32 s60, s4, 3
    s_add_u32 s60, s60, 1
    s_mov_b32 s56, 0
    s_and_b32 s6, s6, 7
    s_lshl_b32 s6, s6, 14
    s_add_u32 s6, s6, 65536
    s_add_u32 s7, s60, 0
    s_and_b32 s7, s7, 3
    s_lshl_b32 s7, s7, 12
    s_add_u32 s64, s6, s7
    s_add_u32 s7, s60, 1
    s_and_b32 s7, s7, 3
    s_lshl_b32 s7, s7, 12
    s_add_u32 s65, s6, s7
    s_add_u32 s7, s60, 2
    s_and_b32 s7, s7, 3
    s_lshl_b32 s7, s7, 12
    s_add_u32 s66, s6, s7
    s_add_u32 s7, s60, 3
    s_and_b32 s7, s7, 3
    s_lshl_b32 s7, s7, 12
    s_add_u32 s67, s6, s7
    s_cmp_lg_u32 s3, 1
    s_cbranch_scc1 L_a_noann
    s_waitcnt lgkmcnt(0)
    s_add_u32 s5, s5, 0x9e3779b1
    s_lshl_b32 s6, s4, 5
    s_add_u32 s6, s6, 32768
    s_setprio 3
    s_waitcnt vmcnt(4)
    v_mov_b32 v24, s5
    v_mov_b32 v25, s5
    v_mov_b32 v26, s5
    v_mov_b32 v27, s5
    s_mov_b64 exec, 3
    buffer_store_dwordx4 v[24:27], v4, s[36:39], s6 offen sc1
    s_mov_b64 exec, -1
    s_branch L_a_x6
L_a_noann:
    s_lshr_b32 s6, s3, 1
    s_cmp_eq_u32 s6, 1
    s_cbranch_scc1 L_a_x6
    s_waitcnt vmcnt(4)
L_a_x5:
    s_waitcnt vmcnt(5)
L_a_x6:
    s_waitcnt vmcnt(6)
L_a_x24:
    s_waitcnt vmcnt(24)
    v_lshlrev_b32 v8, 16, v16
    v_and_b32 v9, 0xffff0000, v16
    v_lshlrev_b32 v10, 16, v17
    v_and_b32 v11, 0xffff0000, v17
    v_lshlrev_b32 v12, 16, v18
    v_and_b32 v13, 0xffff0000, v18
    v_lshlrev_b32 v14, 16, v19
    v_and_b32 v15, 0xffff0000, v19
    v_pk_add_f32 v[104:105], v[8:9], v[10:11]
    v_pk_fma_f32 v[106:107], v[8:9], v[8:9], s[86:87]
    v_pk_add_f32 v[112:113], v[12:13], v[14:15]
    v_pk_fma_f32 v[106:107], v[10:11], v[10:11], v[106:107]
    v_pk_add_f32 v[104:105], v[104:105], v[112:113]
    v_pk_fma_f32 v[106:107], v[12:13], v[12:13], v[106:107]
    v_add_f32 v104, v104, v105
    v_pk_fma_f32 v[106:107], v[14:15], v[14:15], v[106:107]
    v_add_f32 v106, v106, v107
    s_nop 1
    v_permlane32_swap_b32 v104, v106
    v_add_f32 v104, v104, v106
    s_nop 1
    v_add_f32_dpp v104, v104, v104 quad_perm:[1,0,3,2] row_mask:0xf bank_mask:0xf
    s_nop 1
    v_add_f32_dpp v104, v104, v104 quad_perm:[2,3,0,1] row_mask:0xf bank_mask:0xf
    s_nop 1
    v_add_f32_dpp v104, v104, v104 row_half_mirror row_mask:0xf bank_mask:0xf
    s_nop 1
    v_add_f32_dpp v104, v104, v104 row_mirror row_mask:0xf bank_mask:0xf
    s_nop 1
    v_add_f32_dpp v104, v104, v104 row_bcast:15 row_mask:0xa bank_mask:0xf
    v_mul_f32 v104, 0x3b000000, v104
    s_nop 0
    v_readlane_b32 s68, v104, 31
    v_readlane_b32 s69, v104, 63
    s_nop 0
    v_mov_b32 v107, s68
    v_fma_f32 v106, -v107, v107, s69
    v_max_f32 v106, 0x3727c5ac, v106
    v_rsq_f32 v106, v106
    s_nop 0
    v_mul_f32_e64 v107, -v107, v106
    v_pk_fma_f32 v[24:25], v[8:9], v[106:107], v[106:107] op_sel:[0,0,1] op_sel_hi:[1,0,1]
    v_pk_fma_f32 v[26:27], v[10:11], v[106:107], v[106:107] op_sel:[0,0,1] op_sel_hi:[1,0,1]
    v_pk_fma_f32 v[28:29], v[12:13], v[106:107], v[106:107] op_sel:[0,0,1] op_sel_hi:[1,0,1]
    v_pk_fma_f32 v[30:31], v[14:15], v[106:107], v[106:107] op_sel:[0,0,1] op_sel_hi:[1,0,1]
    v_cvt_pk_bf16_f32 v16, v24, v25
    v_cvt_pk_bf16_f32 v17, v26, v27
    v_cvt_pk_bf16_f32 v18, v28, v29
    v_cvt_pk_bf16_f32 v19, v30, v31
    ds_write_b128 v7, v[16:19] offset:12288
    s_waitcnt lgkmcnt(0)
    s_cmp_ge_u32 s3, 2
    s_cbranch_scc1 L_a_n2
    s_setprio 3
    s_cmp_eq_u32 s3, 1
    s_cbranch_scc1 L_a_k1
    s_waitcnt vmcnt(0)
L_a_k1:
    s_waitcnt vmcnt(1)
    s_barrier
    s_xor_b32 s6, s70, 8192
    buffer_load_dwordx4 v[36:39], v4, s[40:43], s6 offen
    ds_read_b64_tr_b16 v[40:41], v120 offset:0
    ds_read_b64_tr_b16 v[42:43], v120 offset:64
    ds_read_b64_tr_b16 v[44:45], v120 offset:1024
    ds_read_b64_tr_b16 v[46:47], v120 offset:1088
    ds_read_b64_tr_b16 v[48:49], v120 offset:2048
    ds_read_b64_tr_b16 v[50:51], v120 offset:2112
    ds_read_b64_tr_b16 v[52:53], v120 offset:3072
    ds_read_b64_tr_b16 v[54:55], v120 offset:3136
    ds_read_b64_tr_b16 v[56:57], v120 offset:4096
    ds_read_b64_tr_b16 v[58:59], v120 offset:4160
    ds_read_b64_tr_b16 v[60:61], v120 offset:5120
    ds_read_b64_tr_b16 v[62:63], v120 offset:5184
    ds_read_b64_tr_b16 v[64:65], v120 offset:6144
    ds_read_b64_tr_b16 v[66:67], v120 offset:6208
    ds_read_b64_tr_b16 v[68:69], v120 offset:7168
    ds_read_b64_tr_b16 v[70:71], v120 offset:7232
    ds_read_b64_tr_b16 v[72:73], v120 offset:8192
    ds_read_b64_tr_b16 v[74:75], v120 offset:8256
    ds_read_b64_tr_b16 v[76:77], v120 offset:9216
    ds_read_b64_tr_b16 v[78:79], v120 offset:9280
    ds_read_b64_tr_b16 v[80:81], v120 offset:10240
    ds_read_b64_tr_b16 v[82:83], v120 offset:10304
    ds_read_b64_tr_b16 v[84:85], v120 offset:11264
    ds_read_b64_tr_b16 v[86:87], v120 offset:11328
    ds_read_b64_tr_b16 v[88:89], v120 offset:12288
    ds_read_b64_tr_b16 v[90:91], v120 offset:12352
    ds_read_b64_tr_b16 v[92:93], v120 offset:13312
    ds_read_b64_tr_b16 v[94:95], v120 offset:13376
    ds_read_b64_tr_b16 v[96:97], v120 offset:14336
    ds_read_b64_tr_b16 v[98:99], v120 offset:14400
    ds_read_b64_tr_b16 v[100:101], v120 offset:15360
    ds_read_b64_tr_b16 v[102:103], v120 offset:15424
    ds_read_b128 v[104:107], v20 offset:12288
    ds_read_b128 v[112:115], v20 offset:13312
    ds_read_b128 v[120:123], v20 offset:14336
    ds_read_b128 v[128:131], v20 offset:15360
    ds_read_b128 v[136:139], v20 offset:16384
    ds_read_b128 v[144:147], v20 offset:17408
    ds_read_b128 v[152:155], v20 offset:18432
    ds_read_b128 v[160:163], v20 offset:19456
    v_and_b32 v32, 1, v0
    v_mul_u32_u24 v32, 0xaaaa, v32
    v_add_u32 v32, 0x4444, v32
    v_mov_b64 v[24:25], 0
    v_mov_b64 v[26:27], 0
    s_lshl_b32 s6, s3, 8
    v_add_u32 v30, s6, v4
    v_and_b32 v28, 0x80, v4
    v_add_u32 v28, s6, v28
    v_and_b32 v29, 7, v0
    v_mad_u32_u24 v28, v29, s72, v28
    v_lshrrev_b32 v29, 4, v0
    v_mad_u32_u24 v28, v29, s73, v28
    v_add_u32 v29, s74, v28
    s_waitcnt lgkmcnt(7)
    v_smfmac_f32_16x16x64_bf16 v[24:27], v[104:107], v[40:47], v32
    s_waitcnt lgkmcnt(6)
    v_smfmac_f32_16x16x64_bf16 v[24:27], v[112:115], v[48:55], v32
    s_waitcnt lgkmcnt(5)
    v_smfmac_f32_16x16x64_bf16 v[24:27], v[120:123], v[56:63], v32
    s_waitcnt lgkmcnt(4)
    v_smfmac_f32_16x16x64_bf16 v[24:27], v[128:131], v[64:71], v32
    s_waitcnt lgkmcnt(3)
    v_smfmac_f32_16x16x64_bf16 v[24:27], v[136:139], v[72:79], v32
    s_waitcnt lgkmcnt(2)
    v_smfmac_f32_16x16x64_bf16 v[24:27], v[144:147], v[80:87], v32
    s_waitcnt lgkmcnt(1)
    v_smfmac_f32_16x16x64_bf16 v[24:27], v[152:155], v[88:95], v32
    s_waitcnt lgkmcnt(0)
    v_smfmac_f32_16x16x64_bf16 v[24:27], v[160:163], v[96:103], v32
    s_nop 7
    v_add_f32 v24, v24, v25
    v_add_f32 v26, v26, v27
    v_mul_f32 v24, s59, v24
    v_mul_f32 v26, s59, v26
    v_cvt_pk_bf16_f32 v24, v24, v26
    ds_write_b16 v28, v24 offset:256
    ds_write_b16_d16_hi v29, v24 offset:256
    s_mov_b64 exec, 0xffff
    ds_read_b128 v[24:27], v30 offset:256
    s_waitcnt lgkmcnt(0)
    buffer_store_dwordx4 v[24:27], v4, s[36:39], s58 offen sc1
    s_mov_b64 exec, -1
    v_add_u32 v28, s75, v4
    ds_write_b128 v28, v[40:43] offset:0
    ds_write_b128 v28, v[44:47] offset:1024
    ds_write_b128 v28, v[48:51] offset:2048
    ds_write_b128 v28, v[52:55] offset:3072
    ds_write_b128 v28, v[56:59] offset:4096
    ds_write_b128 v28, v[60:63] offset:5120
    ds_write_b128 v28, v[64:67] offset:6144
    ds_write_b128 v28, v[68:71] offset:7168
    ds_write_b128 v28, v[72:75] offset:8192
    ds_write_b128 v28, v[76:79] offset:9216
    ds_write_b128 v28, v[80:83] offset:10240
    ds_write_b128 v28, v[84:87] offset:11264
    ds_write_b128 v28, v[88:91] offset:12288
    ds_write_b128 v28, v[92:95] offset:13312
    ds_write_b128 v28, v[96:99] offset:14336
    ds_write_b128 v28, v[100:103] offset:15360
    s_waitcnt vmcnt(1)
    v_lshlrev_b32 v72, 16, v36
    v_and_b32 v73, 0xffff0000, v36
    v_lshlrev_b32 v74, 16, v37
    v_and_b32 v75, 0xffff0000, v37
    v_lshlrev_b32 v76, 16, v38
    v_and_b32 v77, 0xffff0000, v38
    v_lshlrev_b32 v78, 16, v39
    v_and_b32 v79, 0xffff0000, v39
    v_pk_add_f32 v[104:105], v[72:73], v[74:75]
    v_pk_fma_f32 v[106:107], v[72:73], v[72:73], s[86:87]
    v_pk_add_f32 v[112:113], v[76:77], v[78:79]
    v_pk_fma_f32 v[106:107], v[74:75], v[74:75], v[106:107]
    v_pk_add_f32 v[104:105], v[104:105], v[112:113]
    v_pk_fma_f32 v[106:107], v[76:77], v[76:77], v[106:107]
    v_add_f32 v104, v104, v105
    v_pk_fma_f32 v[106:107], v[78:79], v[78:79], v[106:107]
    v_add_f32 v106, v106, v107
    s_nop 1
    v_permlane32_swap_b32 v104, v106
    v_add_f32 v104, v104, v106
    s_nop 1
    v_add_f32_dpp v104, v104, v104 quad_perm:[1,0,3,2] row_mask:0xf bank_mask:0xf
    s_nop 1
    v_add_f32_dpp v104, v104, v104 quad_perm:[2,3,0,1] row_mask:0xf bank_mask:0xf
    s_nop 1
    v_add_f32_dpp v104, v104, v104 row_half_mirror row_mask:0xf bank_mask:0xf
    s_nop 1
    v_add_f32_dpp v104, v104, v104 row_mirror row_mask:0xf bank_mask:0xf
    s_nop 1
    v_add_f32_dpp v104, v104, v104 row_bcast:15 row_mask:0xa bank_mask:0xf
    v_mul_f32 v104, 0x3b000000, v104
    s_nop 0
    v_readlane_b32 s68, v104, 31
    v_readlane_b32 s69, v104, 63
    s_nop 0
    v_mov_b32 v107, s68
    v_fma_f32 v106, -v107, v107, s69
    v_max_f32 v106, 0x3727c5ac, v106
    v_rsq_f32 v106, v106
    s_nop 0
    v_mul_f32_e64 v107, -v107, v106
    v_pk_fma_f32 v[80:81], v[72:73], v[106:107], v[106:107] op_sel:[0,0,1] op_sel_hi:[1,0,1]
    v_pk_fma_f32 v[82:83], v[74:75], v[106:107], v[106:107] op_sel:[0,0,1] op_sel_hi:[1,0,1]
    v_pk_fma_f32 v[84:85], v[76:77], v[106:107], v[106:107] op_sel:[0,0,1] op_sel_hi:[1,0,1]
    v_pk_fma_f32 v[86:87], v[78:79], v[106:107], v[106:107] op_sel:[0,0,1] op_sel_hi:[1,0,1]
    v_cvt_pk_bf16_f32 v72, v80, v81
    v_cvt_pk_bf16_f32 v73, v82, v83
    v_cvt_pk_bf16_f32 v74, v84, v85
    v_cvt_pk_bf16_f32 v75, v86, v87
    ds_write_b128 v7, v[72:75] offset:20480
    s_waitcnt lgkmcnt(0)
    s_waitcnt vmcnt(0) lgkmcnt(0)
    s_barrier
    s_branch L_a_ld
L_a_n2:
    s_cmp_ge_u32 s3, 4
    s_cbranch_scc1 L_a_n4
    s_load_dword s5, s[34:35], 0
    s_waitcnt vmcnt(2)
    s_barrier
    s_xor_b32 s6, s70, 8192
    buffer_load_dwordx4 v[88:91], v4, s[40:43], s6 offen
    s_waitcnt lgkmcnt(0)
    s_add_u32 s5, s5, 0x9e3779b1
    s_waitcnt vmcnt(0) lgkmcnt(0)
    s_cmp_eq_u32 s3, 3
    s_cbranch_scc1 L_a_n3
    ds_read_b64_tr_b16 v[40:41], v120 offset:0
    ds_read_b64_tr_b16 v[42:43], v120 offset:64
    ds_read_b64_tr_b16 v[44:45], v120 offset:1024
    ds_read_b64_tr_b16 v[46:47], v120 offset:1088
    s_waitcnt lgkmcnt(2)
    buffer_store_dwordx4 v[40:43], v4, s[36:39], s76 offen sc1
    s_waitcnt lgkmcnt(0)
    buffer_store_dwordx4 v[44:47], v4, s[36:39], s76 offen offset:1024 sc1
    s_branch L_a_n23
L_a_n3:
    v_and_b32 v56, 0xf0, v4
    v_lshrrev_b32 v57, 4, v0
    v_lshl_add_u32 v58, v57, 11, v56
    v_lshl_add_u32 v56, v57, 1, v56
    ds_read_u16 v40, v56 offset:30720
    ds_read_u16 v41, v56 offset:30976
    ds_read_u16 v42, v56 offset:31744
    ds_read_u16 v43, v56 offset:32000
    ds_read_u16 v44, v56 offset:31232
    ds_read_u16 v45, v56 offset:31488
    ds_read_u16 v46, v56 offset:32256
    ds_read_u16 v47, v56 offset:32512
    ds_read_u16 v48, v56 offset:30728
    ds_read_u16 v49, v56 offset:30984
    ds_read_u16 v50, v56 offset:31752
    ds_read_u16 v51, v56 offset:32008
    ds_read_u16 v52, v56 offset:31240
    ds_read_u16 v53, v56 offset:31496
    ds_read_u16 v54, v56 offset:32264
    ds_read_u16 v55, v56 offset:32520
    s_add_u32 s77, s76, 8192
    s_waitcnt lgkmcnt(14)
    v_lshl_or_b32 v60, v41, 16, v40
    s_waitcnt lgkmcnt(12)
    v_lshl_or_b32 v61, v43, 16, v42
    s_waitcnt lgkmcnt(10)
    v_lshl_or_b32 v62, v45, 16, v44
    s_waitcnt lgkmcnt(8)
    v_lshl_or_b32 v63, v47, 16, v46
    buffer_store_dwordx4 v[60:63], v58, s[36:39], s76 offen sc1
    s_waitcnt lgkmcnt(6)
    v_lshl_or_b32 v64, v49, 16, v48
    s_waitcnt lgkmcnt(4)
    v_lshl_or_b32 v65, v51, 16, v50
    s_waitcnt lgkmcnt(2)
    v_lshl_or_b32 v66, v53, 16, v52
    s_waitcnt lgkmcnt(0)
    v_lshl_or_b32 v67, v55, 16, v54
    buffer_store_dwordx4 v[64:67], v58, s[36:39], s77 offen sc1
L_a_n23:
    v_lshlrev_b32 v72, 16, v88
    v_and_b32 v73, 0xffff0000, v88
    v_lshlrev_b32 v74, 16, v89
    v_and_b32 v75, 0xffff0000, v89
    v_lshlrev_b32 v76, 16, v90
    v_and_b32 v77, 0xffff0000, v90
    v_lshlrev_b32 v78, 16, v91
    v_and_b32 v79, 0xffff0000, v91
    v_pk_add_f32 v[104:105], v[72:73], v[74:75]
    v_pk_fma_f32 v[106:107], v[72:73], v[72:73], s[86:87]
    v_pk_add_f32 v[112:113], v[76:77], v[78:79]
    v_pk_fma_f32 v[106:107], v[74:75], v[74:75], v[106:107]
    v_pk_add_f32 v[104:105], v[104:105], v[112:113]
    v_pk_fma_f32 v[106:107], v[76:77], v[76:77], v[106:107]
    v_add_f32 v104, v104, v105
    v_pk_fma_f32 v[106:107], v[78:79], v[78:79], v[106:107]
    v_add_f32 v106, v106, v107
    s_nop 1
    v_permlane32_swap_b32 v104, v106
    v_add_f32 v104, v104, v106
    s_nop 1
    v_add_f32_dpp v104, v104, v104 quad_perm:[1,0,3,2] row_mask:0xf bank_mask:0xf
    s_nop 1
    v_add_f32_dpp v104, v104, v104 quad_perm:[2,3,0,1] row_mask:0xf bank_mask:0xf
    s_nop 1
    v_add_f32_dpp v104, v104, v104 row_half_mirror row_mask:0xf bank_mask:0xf
    s_nop 1
    v_add_f32_dpp v104, v104, v104 row_mirror row_mask:0xf bank_mask:0xf
    s_nop 1
    v_add_f32_dpp v104, v104, v104 row_bcast:15 row_mask:0xa bank_mask:0xf
    v_mul_f32 v104, 0x3b000000, v104
    s_nop 0
    v_readlane_b32 s68, v104, 31
    v_readlane_b32 s69, v104, 63
    s_nop 0
    v_mov_b32 v107, s68
    v_fma_f32 v106, -v107, v107, s69
    v_max_f32 v106, 0x3727c5ac, v106
    v_rsq_f32 v106, v106
    s_nop 0
    v_mul_f32_e64 v107, -v107, v106
    v_pk_fma_f32 v[80:81], v[72:73], v[106:107], v[106:107] op_sel:[0,0,1] op_sel_hi:[1,0,1]
    v_pk_fma_f32 v[82:83], v[74:75], v[106:107], v[106:107] op_sel:[0,0,1] op_sel_hi:[1,0,1]
    v_pk_fma_f32 v[84:85], v[76:77], v[106:107], v[106:107] op_sel:[0,0,1] op_sel_hi:[1,0,1]
    v_pk_fma_f32 v[86:87], v[78:79], v[106:107], v[106:107] op_sel:[0,0,1] op_sel_hi:[1,0,1]
    v_cvt_pk_bf16_f32 v72, v80, v81
    v_cvt_pk_bf16_f32 v73, v82, v83
    v_cvt_pk_bf16_f32 v74, v84, v85
    v_cvt_pk_bf16_f32 v75, v86, v87
    ds_write_b128 v7, v[72:75] offset:20480
    s_waitcnt lgkmcnt(0)
    s_barrier
    s_branch L_a_ld
L_a_n4:
    s_waitcnt vmcnt(0)
    s_barrier
    s_xor_b32 s6, s70, 8192
    buffer_load_dwordx4 v[88:91], v4, s[40:43], s6 offen
    s_mov_b32 s44, s20
    s_mov_b32 s45, s21
    s_mov_b32 s46, 2097152
    s_mov_b32 s47, 0x20000
    s_mov_b32 s52, s22
    s_mov_b32 s53, s23
    s_mov_b32 s54, 2097152
    s_mov_b32 s55, 0x20000
    s_mov_b32 s40, s24
    s_mov_b32 s41, s25
    s_mov_b32 s42, 4096
    s_mov_b32 s43, 0x20000
    v_lshrrev_b32 v66, 5, v0
    v_and_b32 v67, 31, v0
    v_lshlrev_b32 v68, 13, v66
    v_lshl_add_u32 v68, v67, 2, v68
    s_and_b32 s6, s4, 31
    s_lshr_b32 s62, s4, 5
    s_and_b32 s63, s3, 3
    s_lshl_b32 s6, s6, 16
    s_lshl_b32 s7, s62, 7
    s_add_u32 s6, s6, s7
    s_lshl_b32 s7, s63, 14
    s_add_u32 s60, s6, s7
    s_add_u32 s61, s60, 4096
    s_sub_u32 s6, s60, 3072
    v_add_u32 v69, s6, v68
    s_lshl_b32 s6, s62, 9
    v_lshlrev_b32 v70, 4, v67
    buffer_load_dword v27, v68, s[44:47], s60 offen offset:0
    buffer_load_dword v28, v68, s[44:47], s60 offen offset:1024
    buffer_load_dword v29, v68, s[44:47], s60 offen offset:2048
    buffer_load_dword v30, v68, s[44:47], s60 offen offset:3072
    buffer_load_dword v31, v68, s[44:47], s61 offen offset:0
    buffer_load_dword v32, v68, s[44:47], s61 offen offset:1024
    buffer_load_dword v33, v68, s[44:47], s61 offen offset:2048
    buffer_load_dword v34, v68, s[44:47], s61 offen offset:3072
    buffer_load_dword v35, v68, s[52:55], s60 offen offset:0
    buffer_load_dword v36, v68, s[52:55], s60 offen offset:1024
    buffer_load_dword v37, v68, s[52:55], s60 offen offset:2048
    buffer_load_dword v38, v68, s[52:55], s60 offen offset:3072
    buffer_load_dword v39, v68, s[52:55], s61 offen offset:0
    buffer_load_dword v40, v68, s[52:55], s61 offen offset:1024
    buffer_load_dword v41, v68, s[52:55], s61 offen offset:2048
    buffer_load_dword v42, v68, s[52:55], s61 offen offset:3072
    buffer_load_dword v24, v69, s[44:47], 0 offen offset:0
    buffer_load_dword v25, v69, s[44:47], 0 offen offset:1024
    buffer_load_dword v26, v69, s[44:47], 0 offen offset:2048
    buffer_load_dwordx4 v[44:47], v70, s[40:43], s6 offen
    s_lshl_b32 s6, s63, 1
    s_xor_b32 s6, s6, 7
    v_xor_b32 v68, s6, v66
    v_and_b32 v66, 7, v0
    v_xor_b32 v68, v68, v66
    v_lshlrev_b32 v68, 4, v68
    v_lshl_add_u32 v68, v67, 8, v68
    v_add_u32 v68, 77824, v68
    s_waitcnt vmcnt(20)
    s_waitcnt vmcnt(20)
    v_lshlrev_b32 v72, 16, v88
    v_and_b32 v73, 0xffff0000, v88
    v_lshlrev_b32 v74, 16, v89
    v_and_b32 v75, 0xffff0000, v89
    v_lshlrev_b32 v76, 16, v90
    v_and_b32 v77, 0xffff0000, v90
    v_lshlrev_b32 v78, 16, v91
    v_and_b32 v79, 0xffff0000, v91
    v_pk_add_f32 v[104:105], v[72:73], v[74:75]
    v_pk_fma_f32 v[106:107], v[72:73], v[72:73], s[86:87]
    v_pk_add_f32 v[112:113], v[76:77], v[78:79]
    v_pk_fma_f32 v[106:107], v[74:75], v[74:75], v[106:107]
    v_pk_add_f32 v[104:105], v[104:105], v[112:113]
    v_pk_fma_f32 v[106:107], v[76:77], v[76:77], v[106:107]
    v_add_f32 v104, v104, v105
    v_pk_fma_f32 v[106:107], v[78:79], v[78:79], v[106:107]
    v_add_f32 v106, v106, v107
    s_nop 1
    v_permlane32_swap_b32 v104, v106
    v_add_f32 v104, v104, v106
    s_nop 1
    v_add_f32_dpp v104, v104, v104 quad_perm:[1,0,3,2] row_mask:0xf bank_mask:0xf
    s_nop 1
    v_add_f32_dpp v104, v104, v104 quad_perm:[2,3,0,1] row_mask:0xf bank_mask:0xf
    s_nop 1
    v_add_f32_dpp v104, v104, v104 row_half_mirror row_mask:0xf bank_mask:0xf
    s_nop 1
    v_add_f32_dpp v104, v104, v104 row_mirror row_mask:0xf bank_mask:0xf
    s_nop 1
    v_add_f32_dpp v104, v104, v104 row_bcast:15 row_mask:0xa bank_mask:0xf
    v_mul_f32 v104, 0x3b000000, v104
    s_nop 0
    v_readlane_b32 s68, v104, 31
    v_readlane_b32 s69, v104, 63
    s_nop 0
    v_mov_b32 v107, s68
    v_fma_f32 v106, -v107, v107, s69
    v_max_f32 v106, 0x3727c5ac, v106
    v_rsq_f32 v106, v106
    s_nop 0
    v_mul_f32_e64 v107, -v107, v106
    v_pk_fma_f32 v[80:81], v[72:73], v[106:107], v[106:107] op_sel:[0,0,1] op_sel_hi:[1,0,1]
    v_pk_fma_f32 v[82:83], v[74:75], v[106:107], v[106:107] op_sel:[0,0,1] op_sel_hi:[1,0,1]
    v_pk_fma_f32 v[84:85], v[76:77], v[106:107], v[106:107] op_sel:[0,0,1] op_sel_hi:[1,0,1]
    v_pk_fma_f32 v[86:87], v[78:79], v[106:107], v[106:107] op_sel:[0,0,1] op_sel_hi:[1,0,1]
    v_cvt_pk_bf16_f32 v72, v80, v81
    v_cvt_pk_bf16_f32 v73, v82, v83
    v_cvt_pk_bf16_f32 v74, v84, v85
    v_cvt_pk_bf16_f32 v75, v86, v87
    ds_write_b128 v7, v[72:75] offset:20480
    s_waitcnt lgkmcnt(0)
    s_barrier
    s_setprio 3
    buffer_load_dwordx4 v[72:75], v21, s[36:39], s64 offen offset:0 sc1
    buffer_load_dwordx4 v[104:107], v22, s[36:39], s64 offen offset:0 sc1
    buffer_load_dwordx4 v[76:79], v21, s[36:39], s64 offen offset:2048 sc1
    buffer_load_dwordx4 v[112:115], v22, s[36:39], s64 offen offset:2048 sc1
    buffer_load_dwordx4 v[80:83], v21, s[36:39], s65 offen offset:0 sc1
    buffer_load_dwordx4 v[120:123], v22, s[36:39], s65 offen offset:0 sc1
    s_setprio 2
    s_waitcnt vmcnt(6)
    v_lshlrev_b32 v48, 16, v44
    v_and_b32 v49, 0xffff0000, v44
    v_lshlrev_b32 v50, 16, v45
    v_and_b32 v51, 0xffff0000, v45
    v_lshlrev_b32 v53, 16, v24
    v_lshlrev_b32 v54, 16, v25
    v_lshlrev_b32 v55, 16, v26
    v_lshlrev_b32 v56, 16, v27
    v_lshlrev_b32 v57, 16, v28
    v_lshlrev_b32 v58, 16, v29
    v_lshlrev_b32 v59, 16, v30
    v_lshlrev_b32 v60, 16, v31
    v_lshlrev_b32 v61, 16, v32
    v_lshlrev_b32 v62, 16, v33
    v_lshlrev_b32 v63, 16, v34
    v_mul_f32 v64, v48, v56
    v_fmac_f32 v64, v49, v55
    v_fmac_f32 v64, v50, v54
    v_fmac_f32 v64, v51, v53
    v_lshlrev_b32 v52, 16, v35
    v_mul_f32 v64, v64, v52
    v_mul_f32 v65, v48, v57
    v_fmac_f32 v65, v49, v56
    v_fmac_f32 v65, v50, v55
    v_fmac_f32 v65, v51, v54
    v_lshlrev_b32 v52, 16, v36
    v_mul_f32 v65, v65, v52
    v_cvt_pk_bf16_f32 v19, v65, v64
    v_mul_f32 v64, v48, v58
    v_fmac_f32 v64, v49, v57
    v_fmac_f32 v64, v50, v56
    v_fmac_f32 v64, v51, v55
    v_lshlrev_b32 v52, 16, v37
    v_mul_f32 v64, v64, v52
    v_mul_f32 v65, v48, v59
    v_fmac_f32 v65, v49, v58
    v_fmac_f32 v65, v50, v57
    v_fmac_f32 v65, v51, v56
    v_lshlrev_b32 v52, 16, v38
    v_mul_f32 v65, v65, v52
    v_cvt_pk_bf16_f32 v18, v65, v64
    v_mul_f32 v64, v48, v60
    v_fmac_f32 v64, v49, v59
    v_fmac_f32 v64, v50, v58
    v_fmac_f32 v64, v51, v57
    v_lshlrev_b32 v52, 16, v39
    v_mul_f32 v64, v64, v52
    v_mul_f32 v65, v48, v61
    v_fmac_f32 v65, v49, v60
    v_fmac_f32 v65, v50, v59
    v_fmac_f32 v65, v51, v58
    v_lshlrev_b32 v52, 16, v40
    v_mul_f32 v65, v65, v52
    v_cvt_pk_bf16_f32 v17, v65, v64
    v_mul_f32 v64, v48, v62
    v_fmac_f32 v64, v49, v61
    v_fmac_f32 v64, v50, v60
    v_fmac_f32 v64, v51, v59
    v_lshlrev_b32 v52, 16, v41
    v_mul_f32 v64, v64, v52
    v_mul_f32 v65, v48, v63
    v_fmac_f32 v65, v49, v62
    v_fmac_f32 v65, v50, v61
    v_fmac_f32 v65, v51, v60
    v_lshlrev_b32 v52, 16, v42
    v_mul_f32 v65, v65, v52
    v_cvt_pk_bf16_f32 v16, v65, v64
    ds_write_b128 v68, v[16:19] offset:0
    v_lshlrev_b32 v48, 16, v46
    v_and_b32 v49, 0xffff0000, v46
    v_lshlrev_b32 v50, 16, v47
    v_and_b32 v51, 0xffff0000, v47
    v_and_b32 v53, 0xffff0000, v24
    v_and_b32 v54, 0xffff0000, v25
    v_and_b32 v55, 0xffff0000, v26
    v_and_b32 v56, 0xffff0000, v27
    v_and_b32 v57, 0xffff0000, v28
    v_and_b32 v58, 0xffff0000, v29
    v_and_b32 v59, 0xffff0000, v30
    v_and_b32 v60, 0xffff0000, v31
    v_and_b32 v61, 0xffff0000, v32
    v_and_b32 v62, 0xffff0000, v33
    v_and_b32 v63, 0xffff0000, v34
    v_mul_f32 v64, v48, v56
    v_fmac_f32 v64, v49, v55
    v_fmac_f32 v64, v50, v54
    v_fmac_f32 v64, v51, v53
    v_and_b32 v52, 0xffff0000, v35
    v_mul_f32 v64, v64, v52
    v_mul_f32 v65, v48, v57
    v_fmac_f32 v65, v49, v56
    v_fmac_f32 v65, v50, v55
    v_fmac_f32 v65, v51, v54
    v_and_b32 v52, 0xffff0000, v36
    v_mul_f32 v65, v65, v52
    v_cvt_pk_bf16_f32 v19, v65, v64
    v_mul_f32 v64, v48, v58
    v_fmac_f32 v64, v49, v57
    v_fmac_f32 v64, v50, v56
    v_fmac_f32 v64, v51, v55
    v_and_b32 v52, 0xffff0000, v37
    v_mul_f32 v64, v64, v52
    v_mul_f32 v65, v48, v59
    v_fmac_f32 v65, v49, v58
    v_fmac_f32 v65, v50, v57
    v_fmac_f32 v65, v51, v56
    v_and_b32 v52, 0xffff0000, v38
    v_mul_f32 v65, v65, v52
    v_cvt_pk_bf16_f32 v18, v65, v64
    v_mul_f32 v64, v48, v60
    v_fmac_f32 v64, v49, v59
    v_fmac_f32 v64, v50, v58
    v_fmac_f32 v64, v51, v57
    v_and_b32 v52, 0xffff0000, v39
    v_mul_f32 v64, v64, v52
    v_mul_f32 v65, v48, v61
    v_fmac_f32 v65, v49, v60
    v_fmac_f32 v65, v50, v59
    v_fmac_f32 v65, v51, v58
    v_and_b32 v52, 0xffff0000, v40
    v_mul_f32 v65, v65, v52
    v_cvt_pk_bf16_f32 v17, v65, v64
    v_mul_f32 v64, v48, v62
    v_fmac_f32 v64, v49, v61
    v_fmac_f32 v64, v50, v60
    v_fmac_f32 v64, v51, v59
    v_and_b32 v52, 0xffff0000, v41
    v_mul_f32 v64, v64, v52
    v_mul_f32 v65, v48, v63
    v_fmac_f32 v65, v49, v62
    v_fmac_f32 v65, v50, v61
    v_fmac_f32 v65, v51, v60
    v_and_b32 v52, 0xffff0000, v42
    v_mul_f32 v65, v65, v52
    v_cvt_pk_bf16_f32 v16, v65, v64
    ds_write_b128 v68, v[16:19] offset:128
    s_branch L_a_ld2
L_a_ld:
    s_setprio 3
    buffer_load_dwordx4 v[72:75], v21, s[36:39], s64 offen offset:0 sc1
    buffer_load_dwordx4 v[104:107], v22, s[36:39], s64 offen offset:0 sc1
    buffer_load_dwordx4 v[76:79], v21, s[36:39], s64 offen offset:2048 sc1
    buffer_load_dwordx4 v[112:115], v22, s[36:39], s64 offen offset:2048 sc1
    buffer_load_dwordx4 v[80:83], v21, s[36:39], s65 offen offset:0 sc1
    buffer_load_dwordx4 v[120:123], v22, s[36:39], s65 offen offset:0 sc1
L_a_ld2:
    s_setprio 2
    v_mov_b64 v[24:25], 0
    v_mov_b64 v[26:27], 0
    v_mov_b64 v[28:29], 0
    v_mov_b64 v[30:31], 0
    v_mov_b64 v[32:33], 0
    v_mov_b64 v[34:35], 0
    v_mov_b64 v[36:37], 0
    v_mov_b64 v[38:39], 0
    s_waitcnt lgkmcnt(0)
L_a_q0:
    ds_read_b128 v[40:43], v2 offset:64
    ds_read_b128 v[16:19], v4 offset:1024
    s_waitcnt lgkmcnt(1)
    v_min3_u32 v40, v40, v41, v42
    v_min_u32 v40, v40, v43
    v_cmp_lt_u32 vcc, s56, v40
    s_cbranch_vccz L_a_q0w
    s_waitcnt vmcnt(4)
    v_max_u32 v20, v72, v104
    v_cmp_eq_u32 vcc, -1, v20
    s_cbranch_vccnz L_a_retry0
L_a_back0:
    s_waitcnt lgkmcnt(0)
    v_mfma_f32_32x32x16_bf16 v[40:55], v[72:75], v[16:19], 0
    s_lshr_b32 s6, s3, 1
    s_lshl_b32 s7, s56, 2
    s_add_u32 s6, s6, s7
    s_cmp_eq_u32 s6, 1
    s_cbranch_scc1 L_a_tag
L_a_tagged:
    v_permlane16_swap_b32 v104, v108
    v_permlane16_swap_b32 v105, v109
    v_permlane16_swap_b32 v106, v110
    v_permlane16_swap_b32 v107, v111
    s_nop 2
    v_exp_f32 v40, v40
    buffer_load_dwordx4 v[84:87], v21, s[36:39], s65 offen offset:2048 sc1
    buffer_load_dwordx4 v[128:131], v22, s[36:39], s65 offen offset:2048 sc1
    v_exp_f32 v41, v41
    s_waitcnt vmcnt(4)
    v_max_u32 v20, v76, v112
    v_cmp_eq_u32 vcc, -1, v20
    v_exp_f32 v42, v42
    v_exp_f32 v43, v43
    v_exp_f32 v44, v44
    s_cbranch_vccnz L_a_retry1
L_a_back1:
    v_mfma_f32_32x32x16_bf16 v[56:71], v[76:79], v[16:19], 0
    v_permlane16_swap_b32 v112, v116
    v_permlane16_swap_b32 v113, v117
    v_permlane16_swap_b32 v114, v118
    v_permlane16_swap_b32 v115, v119
    v_exp_f32 v45, v45
    v_exp_f32 v46, v46
    v_exp_f32 v47, v47
    v_exp_f32 v48, v48
    v_exp_f32 v49, v49
    v_smfmac_f32_32x32x32_bf16 v[24:39], v[104:107], v[40:47], v6
    v_exp_f32 v50, v50
    v_exp_f32 v51, v51
    v_exp_f32 v52, v52
    v_exp_f32 v53, v53
    v_exp_f32 v54, v54
    v_exp_f32 v55, v55
    v_exp_f32 v56, v56
    buffer_load_dwordx4 v[88:91], v21, s[36:39], s66 offen offset:0 sc1
    buffer_load_dwordx4 v[136:139], v22, s[36:39], s66 offen offset:0 sc1
    v_exp_f32 v57, v57
    v_smfmac_f32_32x32x32_bf16 v[24:39], v[108:111], v[48:55], v6
    s_waitcnt vmcnt(4)
    v_max_u32 v20, v80, v120
    v_cmp_eq_u32 vcc, -1, v20
    v_exp_f32 v58, v58
    v_exp_f32 v59, v59
    v_exp_f32 v60, v60
    s_cbranch_vccnz L_a_retry2
L_a_back2:
    v_mfma_f32_32x32x16_bf16 v[40:55], v[80:83], v[16:19], 0
    v_permlane16_swap_b32 v120, v124
    v_permlane16_swap_b32 v121, v125
    v_permlane16_swap_b32 v122, v126
    v_permlane16_swap_b32 v123, v127
    v_exp_f32 v61, v61
    v_exp_f32 v62, v62
    v_exp_f32 v63, v63
    v_exp_f32 v64, v64
    v_exp_f32 v65, v65
    v_smfmac_f32_32x32x32_bf16 v[24:39], v[112:115], v[56:63], v6
    v_exp_f32 v66, v66
    v_exp_f32 v67, v67
    v_exp_f32 v68, v68
    v_exp_f32 v69, v69
    v_exp_f32 v70, v70
    v_exp_f32 v71, v71
    s_setprio 1
    v_exp_f32 v40, v40
    buffer_load_dwordx4 v[92:95], v21, s[36:39], s66 offen offset:2048 sc1
    buffer_load_dwordx4 v[144:147], v22, s[36:39], s66 offen offset:2048 sc1
    v_exp_f32 v41, v41
    v_smfmac_f32_32x32x32_bf16 v[24:39], v[116:119], v[64:71], v6
    s_waitcnt vmcnt(4)
    v_max_u32 v20, v84, v128
    v_cmp_eq_u32 vcc, -1, v20
    v_exp_f32 v42, v42
    v_exp_f32 v43, v43
    v_exp_f32 v44, v44
    s_cbranch_vccnz L_a_retry3
L_a_back3:
    v_mfma_f32_32x32x16_bf16 v[56:71], v[84:87], v[16:19], 0
    v_permlane16_swap_b32 v128, v132
    v_permlane16_swap_b32 v129, v133
    v_permlane16_swap_b32 v130, v134
    v_permlane16_swap_b32 v131, v135
    v_exp_f32 v45, v45
    v_exp_f32 v46, v46
    v_exp_f32 v47, v47
    v_exp_f32 v48, v48
    v_exp_f32 v49, v49
    v_smfmac_f32_32x32x32_bf16 v[24:39], v[120:123], v[40:47], v6
    v_exp_f32 v50, v50
    v_exp_f32 v51, v51
    v_exp_f32 v52, v52
    v_exp_f32 v53, v53
    v_exp_f32 v54, v54
    v_exp_f32 v55, v55
    v_exp_f32 v56, v56
    buffer_load_dwordx4 v[96:99], v21, s[36:39], s67 offen offset:0 sc1
    buffer_load_dwordx4 v[152:155], v22, s[36:39], s67 offen offset:0 sc1
    v_exp_f32 v57, v57
    v_smfmac_f32_32x32x32_bf16 v[24:39], v[124:127], v[48:55], v6
    s_waitcnt vmcnt(4)
    v_max_u32 v20, v88, v136
    v_cmp_eq_u32 vcc, -1, v20
    v_exp_f32 v58, v58
    v_exp_f32 v59, v59
    v_exp_f32 v60, v60
    s_cbranch_vccnz L_a_retry4
L_a_back4:
    v_mfma_f32_32x32x16_bf16 v[40:55], v[88:91], v[16:19], 0
    v_permlane16_swap_b32 v136, v140
    v_permlane16_swap_b32 v137, v141
    v_permlane16_swap_b32 v138, v142
    v_permlane16_swap_b32 v139, v143
    v_exp_f32 v61, v61
    v_exp_f32 v62, v62
    v_exp_f32 v63, v63
    v_exp_f32 v64, v64
    v_exp_f32 v65, v65
    v_smfmac_f32_32x32x32_bf16 v[24:39], v[128:131], v[56:63], v6
    v_exp_f32 v66, v66
    v_exp_f32 v67, v67
    v_exp_f32 v68, v68
    v_exp_f32 v69, v69
    v_exp_f32 v70, v70
    v_exp_f32 v71, v71
    v_exp_f32 v40, v40
    buffer_load_dwordx4 v[100:103], v21, s[36:39], s67 offen offset:2048 sc1
    buffer_load_dwordx4 v[160:163], v22, s[36:39], s67 offen offset:2048 sc1
    v_exp_f32 v41, v41
    v_smfmac_f32_32x32x32_bf16 v[24:39], v[132:135], v[64:71], v6
    s_waitcnt vmcnt(4)
    v_max_u32 v20, v92, v144
    v_cmp_eq_u32 vcc, -1, v20
    v_exp_f32 v42, v42
    v_exp_f32 v43, v43
    v_exp_f32 v44, v44
    s_cbranch_vccnz L_a_retry5
L_a_back5:
    v_mfma_f32_32x32x16_bf16 v[56:71], v[92:95], v[16:19], 0
    v_permlane16_swap_b32 v144, v148
    v_permlane16_swap_b32 v145, v149
    v_permlane16_swap_b32 v146, v150
    v_permlane16_swap_b32 v147, v151
    v_exp_f32 v45, v45
    v_exp_f32 v46, v46
    v_exp_f32 v47, v47
    v_exp_f32 v48, v48
    v_exp_f32 v49, v49
    v_smfmac_f32_32x32x32_bf16 v[24:39], v[136:139], v[40:47], v6
    v_exp_f32 v50, v50
    v_exp_f32 v51, v51
    v_exp_f32 v52, v52
    v_exp_f32 v53, v53
    v_exp_f32 v54, v54
    v_exp_f32 v55, v55
    s_setprio 0
    v_exp_f32 v56, v56
    v_exp_f32 v57, v57
    v_smfmac_f32_32x32x32_bf16 v[24:39], v[140:143], v[48:55], v6
    s_waitcnt vmcnt(2)
    v_max_u32 v20, v96, v152
    v_cmp_eq_u32 vcc, -1, v20
    v_exp_f32 v58, v58
    v_exp_f32 v59, v59
    v_exp_f32 v60, v60
    s_cbranch_vccnz L_a_retry6
L_a_back6:
    v_mfma_f32_32x32x16_bf16 v[40:55], v[96:99], v[16:19], 0
    v_permlane16_swap_b32 v152, v156
    v_permlane16_swap_b32 v153, v157
    v_permlane16_swap_b32 v154, v158
    v_permlane16_swap_b32 v155, v159
    v_exp_f32 v61, v61
    v_exp_f32 v62, v62
    v_exp_f32 v63, v63
    v_exp_f32 v64, v64
    v_exp_f32 v65, v65
    v_smfmac_f32_32x32x32_bf16 v[24:39], v[144:147], v[56:63], v6
    v_exp_f32 v66, v66
    v_exp_f32 v67, v67
    v_exp_f32 v68, v68
    v_exp_f32 v69, v69
    v_exp_f32 v70, v70
    v_exp_f32 v71, v71
    s_barrier
    s_setprio 2
    v_exp_f32 v40, v40
    v_exp_f32 v41, v41
    v_smfmac_f32_32x32x32_bf16 v[24:39], v[148:151], v[64:71], v6
    s_waitcnt vmcnt(0)
    v_max_u32 v20, v100, v160
    v_cmp_eq_u32 vcc, -1, v20
    v_exp_f32 v42, v42
    v_exp_f32 v43, v43
    v_exp_f32 v44, v44
    s_cbranch_vccnz L_a_retry7
L_a_back7:
    v_mfma_f32_32x32x16_bf16 v[56:71], v[100:103], v[16:19], 0
    v_permlane16_swap_b32 v160, v164
    v_permlane16_swap_b32 v161, v165
    v_permlane16_swap_b32 v162, v166
    v_permlane16_swap_b32 v163, v167
    ds_read_b128 v[16:19], v4 offset:2048
    v_exp_f32 v45, v45
    v_exp_f32 v46, v46
    v_exp_f32 v47, v47
    v_exp_f32 v48, v48
    v_exp_f32 v49, v49
    v_smfmac_f32_32x32x32_bf16 v[24:39], v[152:155], v[40:47], v6
    v_exp_f32 v50, v50
    v_exp_f32 v51, v51
    v_exp_f32 v52, v52
    v_exp_f32 v53, v53
    v_exp_f32 v54, v54
    v_exp_f32 v55, v55
    s_setprio 1
    v_exp_f32 v56, v56
    v_exp_f32 v57, v57
    v_smfmac_f32_32x32x32_bf16 v[24:39], v[156:159], v[48:55], v6
    v_exp_f32 v58, v58
    v_exp_f32 v59, v59
    v_exp_f32 v60, v60
    s_waitcnt lgkmcnt(0)
    v_mfma_f32_32x32x16_bf16 v[40:55], v[72:75], v[16:19], 0
    v_exp_f32 v61, v61
    v_exp_f32 v62, v62
    v_exp_f32 v63, v63
    v_exp_f32 v64, v64
    v_exp_f32 v65, v65
    v_smfmac_f32_32x32x32_bf16 v[24:39], v[160:163], v[56:63], v6
    v_exp_f32 v66, v66
    v_exp_f32 v67, v67
    v_exp_f32 v68, v68
    v_exp_f32 v69, v69
    v_exp_f32 v70, v70
    v_exp_f32 v71, v71
    v_exp_f32 v40, v40
    v_exp_f32 v41, v41
    v_smfmac_f32_32x32x32_bf16 v[24:39], v[164:167], v[64:71], v6
    v_exp_f32 v42, v42
    v_exp_f32 v43, v43
    v_exp_f32 v44, v44
    v_mfma_f32_32x32x16_bf16 v[56:71], v[76:79], v[16:19], 0
    v_exp_f32 v45, v45
    v_exp_f32 v46, v46
    v_exp_f32 v47, v47
    v_exp_f32 v48, v48
    ds_write_b128 v5, v[24:27]
    ds_write_b128 v5, v[28:31] offset:1024
    ds_write_b32 v1, v32 offset:10240
    v_mfma_f32_32x32x8bf16_1k v[24:39], v[2:3], v[2:3], 0
    v_exp_f32 v49, v49
    v_exp_f32 v50, v50
    v_exp_f32 v51, v51
    v_exp_f32 v52, v52
    v_smfmac_f32_32x32x32_bf16 v[24:39], v[104:107], v[40:47], v6
    v_exp_f32 v53, v53
    v_exp_f32 v54, v54
    v_exp_f32 v55, v55
    s_setprio 0
    v_exp_f32 v56, v56
    v_exp_f32 v57, v57
    v_smfmac_f32_32x32x32_bf16 v[24:39], v[108:111], v[48:55], v6
    v_exp_f32 v58, v58
    v_exp_f32 v59, v59
    v_exp_f32 v60, v60
    v_mfma_f32_32x32x16_bf16 v[40:55], v[80:83], v[16:19], 0
    v_exp_f32 v61, v61
    v_exp_f32 v62, v62
    v_exp_f32 v63, v63
    v_exp_f32 v64, v64
    v_exp_f32 v65, v65
    v_smfmac_f32_32x32x32_bf16 v[24:39], v[112:115], v[56:63], v6
    v_exp_f32 v66, v66
    v_exp_f32 v67, v67
    v_exp_f32 v68, v68
    v_exp_f32 v69, v69
    v_exp_f32 v70, v70
    v_exp_f32 v71, v71
    s_waitcnt lgkmcnt(0)
    s_barrier
    s_setprio 2
    v_exp_f32 v40, v40
    v_exp_f32 v41, v41
    v_smfmac_f32_32x32x32_bf16 v[24:39], v[116:119], v[64:71], v6
    v_exp_f32 v42, v42
    v_exp_f32 v43, v43
    v_exp_f32 v44, v44
    v_mfma_f32_32x32x16_bf16 v[56:71], v[84:87], v[16:19], 0
    v_exp_f32 v45, v45
    v_exp_f32 v46, v46
    v_exp_f32 v47, v47
    v_exp_f32 v48, v48
    v_exp_f32 v49, v49
    v_smfmac_f32_32x32x32_bf16 v[24:39], v[120:123], v[40:47], v6
    v_exp_f32 v50, v50
    v_exp_f32 v51, v51
    v_exp_f32 v52, v52
    v_exp_f32 v53, v53
    v_exp_f32 v54, v54
    v_exp_f32 v55, v55
    s_setprio 1
    v_exp_f32 v56, v56
    v_exp_f32 v57, v57
    v_smfmac_f32_32x32x32_bf16 v[24:39], v[124:127], v[48:55], v6
    v_exp_f32 v58, v58
    v_exp_f32 v59, v59
    v_exp_f32 v60, v60
    v_mfma_f32_32x32x16_bf16 v[40:55], v[88:91], v[16:19], 0
    v_exp_f32 v61, v61
    v_exp_f32 v62, v62
    v_exp_f32 v63, v63
    v_exp_f32 v64, v64
    v_exp_f32 v65, v65
    v_smfmac_f32_32x32x32_bf16 v[24:39], v[128:131], v[56:63], v6
    v_exp_f32 v66, v66
    v_exp_f32 v67, v67
    v_exp_f32 v68, v68
    v_exp_f32 v69, v69
    v_exp_f32 v70, v70
    v_exp_f32 v71, v71
    v_exp_f32 v40, v40
    v_exp_f32 v41, v41
    v_smfmac_f32_32x32x32_bf16 v[24:39], v[132:135], v[64:71], v6
    v_exp_f32 v42, v42
    v_exp_f32 v43, v43
    v_exp_f32 v44, v44
    v_mfma_f32_32x32x16_bf16 v[56:71], v[92:95], v[16:19], 0
    v_exp_f32 v45, v45
    v_exp_f32 v46, v46
    v_exp_f32 v47, v47
    v_exp_f32 v48, v48
    v_exp_f32 v49, v49
    v_smfmac_f32_32x32x32_bf16 v[24:39], v[136:139], v[40:47], v6
    v_exp_f32 v50, v50
    v_exp_f32 v51, v51
    v_exp_f32 v52, v52
    v_exp_f32 v53, v53
    v_exp_f32 v54, v54
    v_exp_f32 v55, v55
    s_setprio 0
    v_exp_f32 v56, v56
    v_exp_f32 v57, v57
    v_smfmac_f32_32x32x32_bf16 v[24:39], v[140:143], v[48:55], v6
    v_exp_f32 v58, v58
    v_exp_f32 v59, v59
    v_exp_f32 v60, v60
    v_mfma_f32_32x32x16_bf16 v[40:55], v[96:99], v[16:19], 0
    v_exp_f32 v61, v61
    v_exp_f32 v62, v62
    v_exp_f32 v63, v63
    v_exp_f32 v64, v64
    v_exp_f32 v65, v65
    v_smfmac_f32_32x32x32_bf16 v[24:39], v[144:147], v[56:63], v6
    v_exp_f32 v66, v66
    v_exp_f32 v67, v67
    v_exp_f32 v68, v68
    v_exp_f32 v69, v69
    v_exp_f32 v70, v70
    v_exp_f32 v71, v71
    s_barrier
    s_setprio 2
    v_exp_f32 v40, v40
    v_exp_f32 v41, v41
    v_smfmac_f32_32x32x32_bf16 v[24:39], v[148:151], v[64:71], v6
    v_exp_f32 v42, v42
    v_exp_f32 v43, v43
    v_exp_f32 v44, v44
    v_mfma_f32_32x32x16_bf16 v[56:71], v[100:103], v[16:19], 0
    ds_read_b128 v[16:19], v4 offset:3072
    v_exp_f32 v45, v45
    v_exp_f32 v46, v46
    v_exp_f32 v47, v47
    v_exp_f32 v48, v48
    v_exp_f32 v49, v49
    v_smfmac_f32_32x32x32_bf16 v[24:39], v[152:155], v[40:47], v6
    v_exp_f32 v50, v50
    v_exp_f32 v51, v51
    v_exp_f32 v52, v52
    v_exp_f32 v53, v53
    v_exp_f32 v54, v54
    v_exp_f32 v55, v55
    s_setprio 1
    v_exp_f32 v56, v56
    v_exp_f32 v57, v57
    v_smfmac_f32_32x32x32_bf16 v[24:39], v[156:159], v[48:55], v6
    v_exp_f32 v58, v58
    v_exp_f32 v59, v59
    v_exp_f32 v60, v60
    s_waitcnt lgkmcnt(0)
    v_mfma_f32_32x32x16_bf16 v[40:55], v[72:75], v[16:19], 0
    v_exp_f32 v61, v61
    v_exp_f32 v62, v62
    v_exp_f32 v63, v63
    v_exp_f32 v64, v64
    v_exp_f32 v65, v65
    v_smfmac_f32_32x32x32_bf16 v[24:39], v[160:163], v[56:63], v6
    v_exp_f32 v66, v66
    v_exp_f32 v67, v67
    v_exp_f32 v68, v68
    v_exp_f32 v69, v69
    v_exp_f32 v70, v70
    v_exp_f32 v71, v71
    v_exp_f32 v40, v40
    v_exp_f32 v41, v41
    v_smfmac_f32_32x32x32_bf16 v[24:39], v[164:167], v[64:71], v6
    v_exp_f32 v42, v42
    v_exp_f32 v43, v43
    v_exp_f32 v44, v44
    v_mfma_f32_32x32x16_bf16 v[56:71], v[76:79], v[16:19], 0
    v_exp_f32 v45, v45
    v_exp_f32 v46, v46
    v_exp_f32 v47, v47
    v_exp_f32 v48, v48
    ds_write_b128 v5, v[24:27]
    ds_write_b128 v5, v[28:31] offset:1024
    ds_write_b32 v1, v32 offset:10240
    v_mfma_f32_32x32x8bf16_1k v[24:39], v[2:3], v[2:3], 0
    v_exp_f32 v49, v49
    v_exp_f32 v50, v50
    v_exp_f32 v51, v51
    v_exp_f32 v52, v52
    v_smfmac_f32_32x32x32_bf16 v[24:39], v[104:107], v[40:47], v6
    v_exp_f32 v53, v53
    v_exp_f32 v54, v54
    v_exp_f32 v55, v55
    s_setprio 0
    v_exp_f32 v56, v56
    v_exp_f32 v57, v57
    v_smfmac_f32_32x32x32_bf16 v[24:39], v[108:111], v[48:55], v6
    v_exp_f32 v58, v58
    v_exp_f32 v59, v59
    v_exp_f32 v60, v60
    v_mfma_f32_32x32x16_bf16 v[40:55], v[80:83], v[16:19], 0
    v_exp_f32 v61, v61
    v_exp_f32 v62, v62
    v_exp_f32 v63, v63
    v_exp_f32 v64, v64
    v_exp_f32 v65, v65
    v_smfmac_f32_32x32x32_bf16 v[24:39], v[112:115], v[56:63], v6
    v_exp_f32 v66, v66
    v_exp_f32 v67, v67
    v_exp_f32 v68, v68
    v_exp_f32 v69, v69
    v_exp_f32 v70, v70
    v_exp_f32 v71, v71
    s_waitcnt lgkmcnt(0)
    s_barrier
    s_setprio 2
    v_exp_f32 v40, v40
    v_exp_f32 v41, v41
    v_smfmac_f32_32x32x32_bf16 v[24:39], v[116:119], v[64:71], v6
    v_exp_f32 v42, v42
    v_exp_f32 v43, v43
    v_exp_f32 v44, v44
    v_mfma_f32_32x32x16_bf16 v[56:71], v[84:87], v[16:19], 0
    v_exp_f32 v45, v45
    v_exp_f32 v46, v46
    v_exp_f32 v47, v47
    v_exp_f32 v48, v48
    v_exp_f32 v49, v49
    v_smfmac_f32_32x32x32_bf16 v[24:39], v[120:123], v[40:47], v6
    v_exp_f32 v50, v50
    v_exp_f32 v51, v51
    v_exp_f32 v52, v52
    v_exp_f32 v53, v53
    v_exp_f32 v54, v54
    v_exp_f32 v55, v55
    s_setprio 1
    v_exp_f32 v56, v56
    v_exp_f32 v57, v57
    v_smfmac_f32_32x32x32_bf16 v[24:39], v[124:127], v[48:55], v6
    v_exp_f32 v58, v58
    v_exp_f32 v59, v59
    v_exp_f32 v60, v60
    v_mfma_f32_32x32x16_bf16 v[40:55], v[88:91], v[16:19], 0
    v_exp_f32 v61, v61
    v_exp_f32 v62, v62
    v_exp_f32 v63, v63
    v_exp_f32 v64, v64
    v_exp_f32 v65, v65
    v_smfmac_f32_32x32x32_bf16 v[24:39], v[128:131], v[56:63], v6
    v_exp_f32 v66, v66
    v_exp_f32 v67, v67
    v_exp_f32 v68, v68
    v_exp_f32 v69, v69
    v_exp_f32 v70, v70
    v_exp_f32 v71, v71
    v_exp_f32 v40, v40
    v_exp_f32 v41, v41
    v_smfmac_f32_32x32x32_bf16 v[24:39], v[132:135], v[64:71], v6
    v_exp_f32 v42, v42
    v_exp_f32 v43, v43
    v_exp_f32 v44, v44
    v_mfma_f32_32x32x16_bf16 v[56:71], v[92:95], v[16:19], 0
    v_exp_f32 v45, v45
    v_exp_f32 v46, v46
    v_exp_f32 v47, v47
    v_exp_f32 v48, v48
    v_exp_f32 v49, v49
    v_smfmac_f32_32x32x32_bf16 v[24:39], v[136:139], v[40:47], v6
    v_exp_f32 v50, v50
    v_exp_f32 v51, v51
    v_exp_f32 v52, v52
    v_exp_f32 v53, v53
    v_exp_f32 v54, v54
    v_exp_f32 v55, v55
    s_setprio 0
    v_exp_f32 v56, v56
    v_exp_f32 v57, v57
    v_smfmac_f32_32x32x32_bf16 v[24:39], v[140:143], v[48:55], v6
    v_exp_f32 v58, v58
    v_exp_f32 v59, v59
    v_exp_f32 v60, v60
    v_mfma_f32_32x32x16_bf16 v[40:55], v[96:99], v[16:19], 0
    v_exp_f32 v61, v61
    v_exp_f32 v62, v62
    v_exp_f32 v63, v63
    v_exp_f32 v64, v64
    v_exp_f32 v65, v65
    v_smfmac_f32_32x32x32_bf16 v[24:39], v[144:147], v[56:63], v6
    v_exp_f32 v66, v66
    v_exp_f32 v67, v67
    v_exp_f32 v68, v68
    v_exp_f32 v69, v69
    v_exp_f32 v70, v70
    v_exp_f32 v71, v71
    s_barrier
    s_setprio 2
    v_exp_f32 v40, v40
    v_exp_f32 v41, v41
    v_smfmac_f32_32x32x32_bf16 v[24:39], v[148:151], v[64:71], v6
    v_exp_f32 v42, v42
    v_exp_f32 v43, v43
    v_exp_f32 v44, v44
    v_mfma_f32_32x32x16_bf16 v[56:71], v[100:103], v[16:19], 0
    ds_read_b128 v[16:19], v4 offset:4096
    v_exp_f32 v45, v45
    v_exp_f32 v46, v46
    v_exp_f32 v47, v47
    v_exp_f32 v48, v48
    v_exp_f32 v49, v49
    v_smfmac_f32_32x32x32_bf16 v[24:39], v[152:155], v[40:47], v6
    v_exp_f32 v50, v50
    v_exp_f32 v51, v51
    v_exp_f32 v52, v52
    v_exp_f32 v53, v53
    v_exp_f32 v54, v54
    v_exp_f32 v55, v55
    s_setprio 1
    v_exp_f32 v56, v56
    v_exp_f32 v57, v57
    v_smfmac_f32_32x32x32_bf16 v[24:39], v[156:159], v[48:55], v6
    v_exp_f32 v58, v58
    v_exp_f32 v59, v59
    v_exp_f32 v60, v60
    s_waitcnt lgkmcnt(0)
    v_mfma_f32_32x32x16_bf16 v[40:55], v[72:75], v[16:19], 0
    v_exp_f32 v61, v61
    v_exp_f32 v62, v62
    v_exp_f32 v63, v63
    v_exp_f32 v64, v64
    v_exp_f32 v65, v65
    v_smfmac_f32_32x32x32_bf16 v[24:39], v[160:163], v[56:63], v6
    v_exp_f32 v66, v66
    v_exp_f32 v67, v67
    v_exp_f32 v68, v68
    v_exp_f32 v69, v69
    v_exp_f32 v70, v70
    v_exp_f32 v71, v71
    v_exp_f32 v40, v40
    v_exp_f32 v41, v41
    v_smfmac_f32_32x32x32_bf16 v[24:39], v[164:167], v[64:71], v6
    v_exp_f32 v42, v42
    v_exp_f32 v43, v43
    v_exp_f32 v44, v44
    v_mfma_f32_32x32x16_bf16 v[56:71], v[76:79], v[16:19], 0
    v_exp_f32 v45, v45
    v_exp_f32 v46, v46
    v_exp_f32 v47, v47
    v_exp_f32 v48, v48
    ds_write_b128 v5, v[24:27]
    ds_write_b128 v5, v[28:31] offset:1024
    ds_write_b32 v1, v32 offset:10240
    v_mfma_f32_32x32x8bf16_1k v[24:39], v[2:3], v[2:3], 0
    v_exp_f32 v49, v49
    v_exp_f32 v50, v50
    v_exp_f32 v51, v51
    v_exp_f32 v52, v52
    v_smfmac_f32_32x32x32_bf16 v[24:39], v[104:107], v[40:47], v6
    v_exp_f32 v53, v53
    v_exp_f32 v54, v54
    v_exp_f32 v55, v55
    s_setprio 0
    v_exp_f32 v56, v56
    v_exp_f32 v57, v57
    v_smfmac_f32_32x32x32_bf16 v[24:39], v[108:111], v[48:55], v6
    v_exp_f32 v58, v58
    v_exp_f32 v59, v59
    v_exp_f32 v60, v60
    v_mfma_f32_32x32x16_bf16 v[40:55], v[80:83], v[16:19], 0
    v_exp_f32 v61, v61
    v_exp_f32 v62, v62
    v_exp_f32 v63, v63
    v_exp_f32 v64, v64
    v_exp_f32 v65, v65
    v_smfmac_f32_32x32x32_bf16 v[24:39], v[112:115], v[56:63], v6
    v_exp_f32 v66, v66
    v_exp_f32 v67, v67
    v_exp_f32 v68, v68
    v_exp_f32 v69, v69
    v_exp_f32 v70, v70
    v_exp_f32 v71, v71
    s_waitcnt lgkmcnt(0)
    s_barrier
    s_setprio 2
    v_exp_f32 v40, v40
    v_exp_f32 v41, v41
    v_smfmac_f32_32x32x32_bf16 v[24:39], v[116:119], v[64:71], v6
    v_exp_f32 v42, v42
    v_exp_f32 v43, v43
    v_exp_f32 v44, v44
    v_mfma_f32_32x32x16_bf16 v[56:71], v[84:87], v[16:19], 0
    v_exp_f32 v45, v45
    v_exp_f32 v46, v46
    v_exp_f32 v47, v47
    v_exp_f32 v48, v48
    v_exp_f32 v49, v49
    v_smfmac_f32_32x32x32_bf16 v[24:39], v[120:123], v[40:47], v6
    v_exp_f32 v50, v50
    v_exp_f32 v51, v51
    v_exp_f32 v52, v52
    v_exp_f32 v53, v53
    v_exp_f32 v54, v54
    v_exp_f32 v55, v55
    s_setprio 1
    v_exp_f32 v56, v56
    v_exp_f32 v57, v57
    v_smfmac_f32_32x32x32_bf16 v[24:39], v[124:127], v[48:55], v6
    v_exp_f32 v58, v58
    v_exp_f32 v59, v59
    v_exp_f32 v60, v60
    v_mfma_f32_32x32x16_bf16 v[40:55], v[88:91], v[16:19], 0
    v_exp_f32 v61, v61
    v_exp_f32 v62, v62
    v_exp_f32 v63, v63
    v_exp_f32 v64, v64
    v_exp_f32 v65, v65
    v_smfmac_f32_32x32x32_bf16 v[24:39], v[128:131], v[56:63], v6
    v_exp_f32 v66, v66
    v_exp_f32 v67, v67
    v_exp_f32 v68, v68
    v_exp_f32 v69, v69
    v_exp_f32 v70, v70
    v_exp_f32 v71, v71
    v_exp_f32 v40, v40
    v_exp_f32 v41, v41
    v_smfmac_f32_32x32x32_bf16 v[24:39], v[132:135], v[64:71], v6
    v_exp_f32 v42, v42
    v_exp_f32 v43, v43
    v_exp_f32 v44, v44
    v_mfma_f32_32x32x16_bf16 v[56:71], v[92:95], v[16:19], 0
    v_exp_f32 v45, v45
    v_exp_f32 v46, v46
    v_exp_f32 v47, v47
    v_exp_f32 v48, v48
    v_exp_f32 v49, v49
    v_smfmac_f32_32x32x32_bf16 v[24:39], v[136:139], v[40:47], v6
    v_exp_f32 v50, v50
    v_exp_f32 v51, v51
    v_exp_f32 v52, v52
    v_exp_f32 v53, v53
    v_exp_f32 v54, v54
    v_exp_f32 v55, v55
    s_setprio 0
    v_exp_f32 v56, v56
    v_exp_f32 v57, v57
    v_smfmac_f32_32x32x32_bf16 v[24:39], v[140:143], v[48:55], v6
    v_exp_f32 v58, v58
    v_exp_f32 v59, v59
    v_exp_f32 v60, v60
    v_mfma_f32_32x32x16_bf16 v[40:55], v[96:99], v[16:19], 0
    v_exp_f32 v61, v61
    v_exp_f32 v62, v62
    v_exp_f32 v63, v63
    v_exp_f32 v64, v64
    v_exp_f32 v65, v65
    v_smfmac_f32_32x32x32_bf16 v[24:39], v[144:147], v[56:63], v6
    v_exp_f32 v66, v66
    v_exp_f32 v67, v67
    v_exp_f32 v68, v68
    v_exp_f32 v69, v69
    v_exp_f32 v70, v70
    v_exp_f32 v71, v71
    s_barrier
    s_setprio 2
    v_exp_f32 v40, v40
    v_exp_f32 v41, v41
    v_smfmac_f32_32x32x32_bf16 v[24:39], v[148:151], v[64:71], v6
    v_exp_f32 v42, v42
    v_exp_f32 v43, v43
    v_exp_f32 v44, v44
    v_mfma_f32_32x32x16_bf16 v[56:71], v[100:103], v[16:19], 0
    ds_read_b128 v[16:19], v4 offset:5120
    v_exp_f32 v45, v45
    v_exp_f32 v46, v46
    v_exp_f32 v47, v47
    v_exp_f32 v48, v48
    v_exp_f32 v49, v49
    v_smfmac_f32_32x32x32_bf16 v[24:39], v[152:155], v[40:47], v6
    v_exp_f32 v50, v50
    v_exp_f32 v51, v51
    v_exp_f32 v52, v52
    v_exp_f32 v53, v53
    v_exp_f32 v54, v54
    v_exp_f32 v55, v55
    s_setprio 1
    v_exp_f32 v56, v56
    v_exp_f32 v57, v57
    v_smfmac_f32_32x32x32_bf16 v[24:39], v[156:159], v[48:55], v6
    v_exp_f32 v58, v58
    v_exp_f32 v59, v59
    v_exp_f32 v60, v60
    s_waitcnt lgkmcnt(0)
    v_mfma_f32_32x32x16_bf16 v[40:55], v[72:75], v[16:19], 0
    v_exp_f32 v61, v61
    v_exp_f32 v62, v62
    v_exp_f32 v63, v63
    v_exp_f32 v64, v64
    v_exp_f32 v65, v65
    v_smfmac_f32_32x32x32_bf16 v[24:39], v[160:163], v[56:63], v6
    v_exp_f32 v66, v66
    v_exp_f32 v67, v67
    v_exp_f32 v68, v68
    v_exp_f32 v69, v69
    v_exp_f32 v70, v70
    v_exp_f32 v71, v71
    v_exp_f32 v40, v40
    v_exp_f32 v41, v41
    v_smfmac_f32_32x32x32_bf16 v[24:39], v[164:167], v[64:71], v6
    v_exp_f32 v42, v42
    v_exp_f32 v43, v43
    v_exp_f32 v44, v44
    v_mfma_f32_32x32x16_bf16 v[56:71], v[76:79], v[16:19], 0
    v_exp_f32 v45, v45
    v_exp_f32 v46, v46
    v_exp_f32 v47, v47
    v_exp_f32 v48, v48
    ds_write_b128 v5, v[24:27]
    ds_write_b128 v5, v[28:31] offset:1024
    ds_write_b32 v1, v32 offset:10240
    v_mfma_f32_32x32x8bf16_1k v[24:39], v[2:3], v[2:3], 0
    v_exp_f32 v49, v49
    v_exp_f32 v50, v50
    v_exp_f32 v51, v51
    v_exp_f32 v52, v52
    v_smfmac_f32_32x32x32_bf16 v[24:39], v[104:107], v[40:47], v6
    v_exp_f32 v53, v53
    v_exp_f32 v54, v54
    v_exp_f32 v55, v55
    s_setprio 0
    v_exp_f32 v56, v56
    v_exp_f32 v57, v57
    v_smfmac_f32_32x32x32_bf16 v[24:39], v[108:111], v[48:55], v6
    v_exp_f32 v58, v58
    v_exp_f32 v59, v59
    v_exp_f32 v60, v60
    v_mfma_f32_32x32x16_bf16 v[40:55], v[80:83], v[16:19], 0
    v_exp_f32 v61, v61
    v_exp_f32 v62, v62
    v_exp_f32 v63, v63
    v_exp_f32 v64, v64
    v_exp_f32 v65, v65
    v_smfmac_f32_32x32x32_bf16 v[24:39], v[112:115], v[56:63], v6
    v_exp_f32 v66, v66
    v_exp_f32 v67, v67
    v_exp_f32 v68, v68
    v_exp_f32 v69, v69
    v_exp_f32 v70, v70
    v_exp_f32 v71, v71
    s_waitcnt lgkmcnt(0)
    s_barrier
    s_setprio 2
    v_exp_f32 v40, v40
    v_exp_f32 v41, v41
    v_smfmac_f32_32x32x32_bf16 v[24:39], v[116:119], v[64:71], v6
    v_exp_f32 v42, v42
    v_exp_f32 v43, v43
    v_exp_f32 v44, v44
    v_mfma_f32_32x32x16_bf16 v[56:71], v[84:87], v[16:19], 0
    v_exp_f32 v45, v45
    v_exp_f32 v46, v46
    v_exp_f32 v47, v47
    v_exp_f32 v48, v48
    v_exp_f32 v49, v49
    v_smfmac_f32_32x32x32_bf16 v[24:39], v[120:123], v[40:47], v6
    v_exp_f32 v50, v50
    v_exp_f32 v51, v51
    v_exp_f32 v52, v52
    v_exp_f32 v53, v53
    v_exp_f32 v54, v54
    v_exp_f32 v55, v55
    s_setprio 1
    v_exp_f32 v56, v56
    v_exp_f32 v57, v57
    v_smfmac_f32_32x32x32_bf16 v[24:39], v[124:127], v[48:55], v6
    v_exp_f32 v58, v58
    v_exp_f32 v59, v59
    v_exp_f32 v60, v60
    v_mfma_f32_32x32x16_bf16 v[40:55], v[88:91], v[16:19], 0
    v_exp_f32 v61, v61
    v_exp_f32 v62, v62
    v_exp_f32 v63, v63
    v_exp_f32 v64, v64
    v_exp_f32 v65, v65
    v_smfmac_f32_32x32x32_bf16 v[24:39], v[128:131], v[56:63], v6
    v_exp_f32 v66, v66
    v_exp_f32 v67, v67
    v_exp_f32 v68, v68
    v_exp_f32 v69, v69
    v_exp_f32 v70, v70
    v_exp_f32 v71, v71
    v_exp_f32 v40, v40
    v_exp_f32 v41, v41
    v_smfmac_f32_32x32x32_bf16 v[24:39], v[132:135], v[64:71], v6
    v_exp_f32 v42, v42
    v_exp_f32 v43, v43
    v_exp_f32 v44, v44
    v_mfma_f32_32x32x16_bf16 v[56:71], v[92:95], v[16:19], 0
    v_exp_f32 v45, v45
    v_exp_f32 v46, v46
    v_exp_f32 v47, v47
    v_exp_f32 v48, v48
    v_exp_f32 v49, v49
    v_smfmac_f32_32x32x32_bf16 v[24:39], v[136:139], v[40:47], v6
    v_exp_f32 v50, v50
    v_exp_f32 v51, v51
    v_exp_f32 v52, v52
    v_exp_f32 v53, v53
    v_exp_f32 v54, v54
    v_exp_f32 v55, v55
    s_setprio 0
    v_exp_f32 v56, v56
    v_exp_f32 v57, v57
    v_smfmac_f32_32x32x32_bf16 v[24:39], v[140:143], v[48:55], v6
    v_exp_f32 v58, v58
    v_exp_f32 v59, v59
    v_exp_f32 v60, v60
    v_mfma_f32_32x32x16_bf16 v[40:55], v[96:99], v[16:19], 0
    v_exp_f32 v61, v61
    v_exp_f32 v62, v62
    v_exp_f32 v63, v63
    v_exp_f32 v64, v64
    v_exp_f32 v65, v65
    v_smfmac_f32_32x32x32_bf16 v[24:39], v[144:147], v[56:63], v6
    v_exp_f32 v66, v66
    v_exp_f32 v67, v67
    v_exp_f32 v68, v68
    v_exp_f32 v69, v69
    v_exp_f32 v70, v70
    v_exp_f32 v71, v71
    s_barrier
    s_setprio 2
    v_exp_f32 v40, v40
    v_exp_f32 v41, v41
    v_smfmac_f32_32x32x32_bf16 v[24:39], v[148:151], v[64:71], v6
    v_exp_f32 v42, v42
    v_exp_f32 v43, v43
    v_exp_f32 v44, v44
    v_mfma_f32_32x32x16_bf16 v[56:71], v[100:103], v[16:19], 0
    ds_read_b128 v[16:19], v4 offset:6144
    v_exp_f32 v45, v45
    v_exp_f32 v46, v46
    v_exp_f32 v47, v47
    v_exp_f32 v48, v48
    v_exp_f32 v49, v49
    v_smfmac_f32_32x32x32_bf16 v[24:39], v[152:155], v[40:47], v6
    v_exp_f32 v50, v50
    v_exp_f32 v51, v51
    v_exp_f32 v52, v52
    v_exp_f32 v53, v53
    v_exp_f32 v54, v54
    v_exp_f32 v55, v55
    s_setprio 1
    v_exp_f32 v56, v56
    v_exp_f32 v57, v57
    v_smfmac_f32_32x32x32_bf16 v[24:39], v[156:159], v[48:55], v6
    v_exp_f32 v58, v58
    v_exp_f32 v59, v59
    v_exp_f32 v60, v60
    s_waitcnt lgkmcnt(0)
    v_mfma_f32_32x32x16_bf16 v[40:55], v[72:75], v[16:19], 0
    v_exp_f32 v61, v61
    v_exp_f32 v62, v62
    v_exp_f32 v63, v63
    v_exp_f32 v64, v64
    v_exp_f32 v65, v65
    v_smfmac_f32_32x32x32_bf16 v[24:39], v[160:163], v[56:63], v6
    v_exp_f32 v66, v66
    v_exp_f32 v67, v67
    v_exp_f32 v68, v68
    v_exp_f32 v69, v69
    v_exp_f32 v70, v70
    v_exp_f32 v71, v71
    v_exp_f32 v40, v40
    v_exp_f32 v41, v41
    v_smfmac_f32_32x32x32_bf16 v[24:39], v[164:167], v[64:71], v6
    v_exp_f32 v42, v42
    v_exp_f32 v43, v43
    v_exp_f32 v44, v44
    v_mfma_f32_32x32x16_bf16 v[56:71], v[76:79], v[16:19], 0
    v_exp_f32 v45, v45
    v_exp_f32 v46, v46
    v_exp_f32 v47, v47
    v_exp_f32 v48, v48
    ds_write_b128 v5, v[24:27]
    ds_write_b128 v5, v[28:31] offset:1024
    ds_write_b32 v1, v32 offset:10240
    v_mfma_f32_32x32x8bf16_1k v[24:39], v[2:3], v[2:3], 0
    v_exp_f32 v49, v49
    v_exp_f32 v50, v50
    v_exp_f32 v51, v51
    v_exp_f32 v52, v52
    v_smfmac_f32_32x32x32_bf16 v[24:39], v[104:107], v[40:47], v6
    v_exp_f32 v53, v53
    v_exp_f32 v54, v54
    v_exp_f32 v55, v55
    s_setprio 0
    v_exp_f32 v56, v56
    v_exp_f32 v57, v57
    v_smfmac_f32_32x32x32_bf16 v[24:39], v[108:111], v[48:55], v6
    v_exp_f32 v58, v58
    v_exp_f32 v59, v59
    v_exp_f32 v60, v60
    v_mfma_f32_32x32x16_bf16 v[40:55], v[80:83], v[16:19], 0
    v_exp_f32 v61, v61
    v_exp_f32 v62, v62
    v_exp_f32 v63, v63
    v_exp_f32 v64, v64
    v_exp_f32 v65, v65
    v_smfmac_f32_32x32x32_bf16 v[24:39], v[112:115], v[56:63], v6
    v_exp_f32 v66, v66
    v_exp_f32 v67, v67
    v_exp_f32 v68, v68
    v_exp_f32 v69, v69
    v_exp_f32 v70, v70
    v_exp_f32 v71, v71
    s_waitcnt lgkmcnt(0)
    s_barrier
    s_setprio 2
    v_exp_f32 v40, v40
    v_exp_f32 v41, v41
    v_smfmac_f32_32x32x32_bf16 v[24:39], v[116:119], v[64:71], v6
    v_exp_f32 v42, v42
    v_exp_f32 v43, v43
    v_exp_f32 v44, v44
    v_mfma_f32_32x32x16_bf16 v[56:71], v[84:87], v[16:19], 0
    v_exp_f32 v45, v45
    v_exp_f32 v46, v46
    v_exp_f32 v47, v47
    v_exp_f32 v48, v48
    v_exp_f32 v49, v49
    v_smfmac_f32_32x32x32_bf16 v[24:39], v[120:123], v[40:47], v6
    v_exp_f32 v50, v50
    v_exp_f32 v51, v51
    v_exp_f32 v52, v52
    v_exp_f32 v53, v53
    v_exp_f32 v54, v54
    v_exp_f32 v55, v55
    s_setprio 1
    v_exp_f32 v56, v56
    v_exp_f32 v57, v57
    v_smfmac_f32_32x32x32_bf16 v[24:39], v[124:127], v[48:55], v6
    v_exp_f32 v58, v58
    v_exp_f32 v59, v59
    v_exp_f32 v60, v60
    v_mfma_f32_32x32x16_bf16 v[40:55], v[88:91], v[16:19], 0
    v_exp_f32 v61, v61
    v_exp_f32 v62, v62
    v_exp_f32 v63, v63
    v_exp_f32 v64, v64
    v_exp_f32 v65, v65
    v_smfmac_f32_32x32x32_bf16 v[24:39], v[128:131], v[56:63], v6
    v_exp_f32 v66, v66
    v_exp_f32 v67, v67
    v_exp_f32 v68, v68
    v_exp_f32 v69, v69
    v_exp_f32 v70, v70
    v_exp_f32 v71, v71
    v_exp_f32 v40, v40
    v_exp_f32 v41, v41
    v_smfmac_f32_32x32x32_bf16 v[24:39], v[132:135], v[64:71], v6
    v_exp_f32 v42, v42
    v_exp_f32 v43, v43
    v_exp_f32 v44, v44
    v_mfma_f32_32x32x16_bf16 v[56:71], v[92:95], v[16:19], 0
    v_exp_f32 v45, v45
    v_exp_f32 v46, v46
    v_exp_f32 v47, v47
    v_exp_f32 v48, v48
    v_exp_f32 v49, v49
    v_smfmac_f32_32x32x32_bf16 v[24:39], v[136:139], v[40:47], v6
    v_exp_f32 v50, v50
    v_exp_f32 v51, v51
    v_exp_f32 v52, v52
    v_exp_f32 v53, v53
    v_exp_f32 v54, v54
    v_exp_f32 v55, v55
    s_setprio 0
    v_exp_f32 v56, v56
    v_exp_f32 v57, v57
    v_smfmac_f32_32x32x32_bf16 v[24:39], v[140:143], v[48:55], v6
    v_exp_f32 v58, v58
    v_exp_f32 v59, v59
    v_exp_f32 v60, v60
    v_mfma_f32_32x32x16_bf16 v[40:55], v[96:99], v[16:19], 0
    v_exp_f32 v61, v61
    v_exp_f32 v62, v62
    v_exp_f32 v63, v63
    v_exp_f32 v64, v64
    v_exp_f32 v65, v65
    v_smfmac_f32_32x32x32_bf16 v[24:39], v[144:147], v[56:63], v6
    v_exp_f32 v66, v66
    v_exp_f32 v67, v67
    v_exp_f32 v68, v68
    v_exp_f32 v69, v69
    v_exp_f32 v70, v70
    v_exp_f32 v71, v71
    s_barrier
    s_setprio 2
    v_exp_f32 v40, v40
    v_exp_f32 v41, v41
    v_smfmac_f32_32x32x32_bf16 v[24:39], v[148:151], v[64:71], v6
    v_exp_f32 v42, v42
    v_exp_f32 v43, v43
    v_exp_f32 v44, v44
    v_mfma_f32_32x32x16_bf16 v[56:71], v[100:103], v[16:19], 0
    ds_read_b128 v[16:19], v4 offset:7168
    v_exp_f32 v45, v45
    v_exp_f32 v46, v46
    v_exp_f32 v47, v47
    v_exp_f32 v48, v48
    v_exp_f32 v49, v49
    v_smfmac_f32_32x32x32_bf16 v[24:39], v[152:155], v[40:47], v6
    v_exp_f32 v50, v50
    v_exp_f32 v51, v51
    v_exp_f32 v52, v52
    v_exp_f32 v53, v53
    v_exp_f32 v54, v54
    v_exp_f32 v55, v55
    s_setprio 1
    v_exp_f32 v56, v56
    v_exp_f32 v57, v57
    v_smfmac_f32_32x32x32_bf16 v[24:39], v[156:159], v[48:55], v6
    v_exp_f32 v58, v58
    v_exp_f32 v59, v59
    v_exp_f32 v60, v60
    s_waitcnt lgkmcnt(0)
    v_mfma_f32_32x32x16_bf16 v[40:55], v[72:75], v[16:19], 0
    v_exp_f32 v61, v61
    v_exp_f32 v62, v62
    v_exp_f32 v63, v63
    v_exp_f32 v64, v64
    v_exp_f32 v65, v65
    v_smfmac_f32_32x32x32_bf16 v[24:39], v[160:163], v[56:63], v6
    v_exp_f32 v66, v66
    v_exp_f32 v67, v67
    v_exp_f32 v68, v68
    v_exp_f32 v69, v69
    v_exp_f32 v70, v70
    v_exp_f32 v71, v71
    v_exp_f32 v40, v40
    v_exp_f32 v41, v41
    v_smfmac_f32_32x32x32_bf16 v[24:39], v[164:167], v[64:71], v6
    v_exp_f32 v42, v42
    v_exp_f32 v43, v43
    v_exp_f32 v44, v44
    v_mfma_f32_32x32x16_bf16 v[56:71], v[76:79], v[16:19], 0
    v_exp_f32 v45, v45
    v_exp_f32 v46, v46
    v_exp_f32 v47, v47
    v_exp_f32 v48, v48
    ds_write_b128 v5, v[24:27]
    ds_write_b128 v5, v[28:31] offset:1024
    ds_write_b32 v1, v32 offset:10240
    v_mfma_f32_32x32x8bf16_1k v[24:39], v[2:3], v[2:3], 0
    v_exp_f32 v49, v49
    v_exp_f32 v50, v50
    v_exp_f32 v51, v51
    v_exp_f32 v52, v52
    v_smfmac_f32_32x32x32_bf16 v[24:39], v[104:107], v[40:47], v6
    v_exp_f32 v53, v53
    v_exp_f32 v54, v54
    v_exp_f32 v55, v55
    s_setprio 0
    v_exp_f32 v56, v56
    v_exp_f32 v57, v57
    v_smfmac_f32_32x32x32_bf16 v[24:39], v[108:111], v[48:55], v6
    v_exp_f32 v58, v58
    v_exp_f32 v59, v59
    v_exp_f32 v60, v60
    v_mfma_f32_32x32x16_bf16 v[40:55], v[80:83], v[16:19], 0
    v_exp_f32 v61, v61
    v_exp_f32 v62, v62
    v_exp_f32 v63, v63
    v_exp_f32 v64, v64
    v_exp_f32 v65, v65
    v_smfmac_f32_32x32x32_bf16 v[24:39], v[112:115], v[56:63], v6
    v_exp_f32 v66, v66
    v_exp_f32 v67, v67
    v_exp_f32 v68, v68
    v_exp_f32 v69, v69
    v_exp_f32 v70, v70
    v_exp_f32 v71, v71
    s_waitcnt lgkmcnt(0)
    s_barrier
    s_setprio 2
    v_exp_f32 v40, v40
    v_exp_f32 v41, v41
    v_smfmac_f32_32x32x32_bf16 v[24:39], v[116:119], v[64:71], v6
    v_exp_f32 v42, v42
    v_exp_f32 v43, v43
    v_exp_f32 v44, v44
    v_mfma_f32_32x32x16_bf16 v[56:71], v[84:87], v[16:19], 0
    v_exp_f32 v45, v45
    v_exp_f32 v46, v46
    v_exp_f32 v47, v47
    v_exp_f32 v48, v48
    v_exp_f32 v49, v49
    v_smfmac_f32_32x32x32_bf16 v[24:39], v[120:123], v[40:47], v6
    v_exp_f32 v50, v50
    v_exp_f32 v51, v51
    v_exp_f32 v52, v52
    v_exp_f32 v53, v53
    v_exp_f32 v54, v54
    v_exp_f32 v55, v55
    s_setprio 1
    v_exp_f32 v56, v56
    v_exp_f32 v57, v57
    v_smfmac_f32_32x32x32_bf16 v[24:39], v[124:127], v[48:55], v6
    v_exp_f32 v58, v58
    v_exp_f32 v59, v59
    v_exp_f32 v60, v60
    v_mfma_f32_32x32x16_bf16 v[40:55], v[88:91], v[16:19], 0
    v_exp_f32 v61, v61
    v_exp_f32 v62, v62
    v_exp_f32 v63, v63
    v_exp_f32 v64, v64
    v_exp_f32 v65, v65
    v_smfmac_f32_32x32x32_bf16 v[24:39], v[128:131], v[56:63], v6
    v_exp_f32 v66, v66
    v_exp_f32 v67, v67
    v_exp_f32 v68, v68
    v_exp_f32 v69, v69
    v_exp_f32 v70, v70
    v_exp_f32 v71, v71
    v_exp_f32 v40, v40
    v_exp_f32 v41, v41
    v_smfmac_f32_32x32x32_bf16 v[24:39], v[132:135], v[64:71], v6
    v_exp_f32 v42, v42
    v_exp_f32 v43, v43
    v_exp_f32 v44, v44
    v_mfma_f32_32x32x16_bf16 v[56:71], v[92:95], v[16:19], 0
    v_exp_f32 v45, v45
    v_exp_f32 v46, v46
    v_exp_f32 v47, v47
    v_exp_f32 v48, v48
    v_exp_f32 v49, v49
    v_smfmac_f32_32x32x32_bf16 v[24:39], v[136:139], v[40:47], v6
    v_exp_f32 v50, v50
    v_exp_f32 v51, v51
    v_exp_f32 v52, v52
    v_exp_f32 v53, v53
    v_exp_f32 v54, v54
    v_exp_f32 v55, v55
    s_setprio 0
    v_exp_f32 v56, v56
    v_exp_f32 v57, v57
    v_smfmac_f32_32x32x32_bf16 v[24:39], v[140:143], v[48:55], v6
    v_exp_f32 v58, v58
    v_exp_f32 v59, v59
    v_exp_f32 v60, v60
    v_mfma_f32_32x32x16_bf16 v[40:55], v[96:99], v[16:19], 0
    v_exp_f32 v61, v61
    v_exp_f32 v62, v62
    v_exp_f32 v63, v63
    v_exp_f32 v64, v64
    v_exp_f32 v65, v65
    v_smfmac_f32_32x32x32_bf16 v[24:39], v[144:147], v[56:63], v6
    v_exp_f32 v66, v66
    v_exp_f32 v67, v67
    v_exp_f32 v68, v68
    v_exp_f32 v69, v69
    v_exp_f32 v70, v70
    v_exp_f32 v71, v71
    s_barrier
    s_setprio 2
    v_exp_f32 v40, v40
    v_exp_f32 v41, v41
    v_smfmac_f32_32x32x32_bf16 v[24:39], v[148:151], v[64:71], v6
    v_exp_f32 v42, v42
    v_exp_f32 v43, v43
    v_exp_f32 v44, v44
    v_mfma_f32_32x32x16_bf16 v[56:71], v[100:103], v[16:19], 0
    ds_read_b128 v[16:19], v4 offset:8192
    v_exp_f32 v45, v45
    v_exp_f32 v46, v46
    v_exp_f32 v47, v47
    v_exp_f32 v48, v48
    v_exp_f32 v49, v49
    v_smfmac_f32_32x32x32_bf16 v[24:39], v[152:155], v[40:47], v6
    v_exp_f32 v50, v50
    v_exp_f32 v51, v51
    v_exp_f32 v52, v52
    v_exp_f32 v53, v53
    v_exp_f32 v54, v54
    v_exp_f32 v55, v55
    s_setprio 1
    v_exp_f32 v56, v56
    v_exp_f32 v57, v57
    v_smfmac_f32_32x32x32_bf16 v[24:39], v[156:159], v[48:55], v6
    v_exp_f32 v58, v58
    v_exp_f32 v59, v59
    v_exp_f32 v60, v60
    s_waitcnt lgkmcnt(0)
    v_mfma_f32_32x32x16_bf16 v[40:55], v[72:75], v[16:19], 0
    v_exp_f32 v61, v61
    v_exp_f32 v62, v62
    v_exp_f32 v63, v63
    v_exp_f32 v64, v64
    v_exp_f32 v65, v65
    v_smfmac_f32_32x32x32_bf16 v[24:39], v[160:163], v[56:63], v6
    v_exp_f32 v66, v66
    v_exp_f32 v67, v67
    v_exp_f32 v68, v68
    v_exp_f32 v69, v69
    v_exp_f32 v70, v70
    v_exp_f32 v71, v71
    v_exp_f32 v40, v40
    v_exp_f32 v41, v41
    v_smfmac_f32_32x32x32_bf16 v[24:39], v[164:167], v[64:71], v6
    v_exp_f32 v42, v42
    v_exp_f32 v43, v43
    v_exp_f32 v44, v44
    v_mfma_f32_32x32x16_bf16 v[56:71], v[76:79], v[16:19], 0
    v_exp_f32 v45, v45
    v_exp_f32 v46, v46
    v_exp_f32 v47, v47
    v_exp_f32 v48, v48
    ds_write_b128 v5, v[24:27]
    ds_write_b128 v5, v[28:31] offset:1024
    ds_write_b32 v1, v32 offset:10240
    v_mfma_f32_32x32x8bf16_1k v[24:39], v[2:3], v[2:3], 0
    v_exp_f32 v49, v49
    v_exp_f32 v50, v50
    v_exp_f32 v51, v51
    v_exp_f32 v52, v52
    v_smfmac_f32_32x32x32_bf16 v[24:39], v[104:107], v[40:47], v6
    v_exp_f32 v53, v53
    v_exp_f32 v54, v54
    v_exp_f32 v55, v55
    s_setprio 0
    v_exp_f32 v56, v56
    v_exp_f32 v57, v57
    v_smfmac_f32_32x32x32_bf16 v[24:39], v[108:111], v[48:55], v6
    v_exp_f32 v58, v58
    v_exp_f32 v59, v59
    v_exp_f32 v60, v60
    v_mfma_f32_32x32x16_bf16 v[40:55], v[80:83], v[16:19], 0
    v_exp_f32 v61, v61
    v_exp_f32 v62, v62
    v_exp_f32 v63, v63
    v_exp_f32 v64, v64
    v_exp_f32 v65, v65
    v_smfmac_f32_32x32x32_bf16 v[24:39], v[112:115], v[56:63], v6
    v_exp_f32 v66, v66
    v_exp_f32 v67, v67
    v_exp_f32 v68, v68
    v_exp_f32 v69, v69
    v_exp_f32 v70, v70
    v_exp_f32 v71, v71
    s_waitcnt lgkmcnt(0)
    s_barrier
    s_setprio 1
    v_exp_f32 v40, v40
    v_exp_f32 v41, v41
    v_smfmac_f32_32x32x32_bf16 v[24:39], v[116:119], v[64:71], v6
    v_exp_f32 v42, v42
    v_exp_f32 v43, v43
    v_exp_f32 v44, v44
    v_mfma_f32_32x32x16_bf16 v[56:71], v[84:87], v[16:19], 0
    v_exp_f32 v45, v45
    v_exp_f32 v46, v46
    v_exp_f32 v47, v47
    v_exp_f32 v48, v48
    v_exp_f32 v49, v49
    v_smfmac_f32_32x32x32_bf16 v[24:39], v[120:123], v[40:47], v6
    v_exp_f32 v50, v50
    v_exp_f32 v51, v51
    v_exp_f32 v52, v52
    v_exp_f32 v53, v53
    v_exp_f32 v54, v54
    v_exp_f32 v55, v55
    s_setprio 0
    v_exp_f32 v56, v56
    v_exp_f32 v57, v57
    v_smfmac_f32_32x32x32_bf16 v[24:39], v[124:127], v[48:55], v6
    v_exp_f32 v58, v58
    v_exp_f32 v59, v59
    v_exp_f32 v60, v60
    v_mfma_f32_32x32x16_bf16 v[40:55], v[88:91], v[16:19], 0
    v_exp_f32 v61, v61
    v_exp_f32 v62, v62
    v_exp_f32 v63, v63
    v_exp_f32 v64, v64
    v_exp_f32 v65, v65
    v_smfmac_f32_32x32x32_bf16 v[24:39], v[128:131], v[56:63], v6
    v_exp_f32 v66, v66
    v_exp_f32 v67, v67
    v_exp_f32 v68, v68
    v_exp_f32 v69, v69
    v_exp_f32 v70, v70
    v_exp_f32 v71, v71
    s_barrier
    s_setprio 2
    v_exp_f32 v40, v40
    v_exp_f32 v41, v41
    v_smfmac_f32_32x32x32_bf16 v[24:39], v[132:135], v[64:71], v6
    v_exp_f32 v42, v42
    v_exp_f32 v43, v43
    v_exp_f32 v44, v44
    v_mfma_f32_32x32x16_bf16 v[56:71], v[92:95], v[16:19], 0
    v_exp_f32 v45, v45
    v_exp_f32 v46, v46
    v_exp_f32 v47, v47
    v_exp_f32 v48, v48
    v_exp_f32 v49, v49
    v_smfmac_f32_32x32x32_bf16 v[24:39], v[136:139], v[40:47], v6
    v_exp_f32 v50, v50
    v_exp_f32 v51, v51
    v_exp_f32 v52, v52
    v_exp_f32 v53, v53
    v_exp_f32 v54, v54
    v_exp_f32 v55, v55
    s_setprio 1
    v_exp_f32 v56, v56
    v_exp_f32 v57, v57
    v_smfmac_f32_32x32x32_bf16 v[24:39], v[140:143], v[48:55], v6
    v_exp_f32 v58, v58
    v_exp_f32 v59, v59
    v_exp_f32 v60, v60
    v_mfma_f32_32x32x16_bf16 v[40:55], v[96:99], v[16:19], 0
    v_exp_f32 v61, v61
    v_exp_f32 v62, v62
    v_exp_f32 v63, v63
    v_exp_f32 v64, v64
    v_exp_f32 v65, v65
    v_smfmac_f32_32x32x32_bf16 v[24:39], v[144:147], v[56:63], v6
    v_exp_f32 v66, v66
    v_exp_f32 v67, v67
    v_exp_f32 v68, v68
    v_exp_f32 v69, v69
    v_exp_f32 v70, v70
    v_exp_f32 v71, v71
    v_exp_f32 v40, v40
    v_exp_f32 v41, v41
    v_smfmac_f32_32x32x32_bf16 v[24:39], v[148:151], v[64:71], v6
    v_exp_f32 v42, v42
    v_exp_f32 v43, v43
    v_exp_f32 v44, v44
    v_mfma_f32_32x32x16_bf16 v[56:71], v[100:103], v[16:19], 0
    v_exp_f32 v45, v45
    v_exp_f32 v46, v46
    v_exp_f32 v47, v47
    v_exp_f32 v48, v48
    v_exp_f32 v49, v49
    v_smfmac_f32_32x32x32_bf16 v[24:39], v[152:155], v[40:47], v6
    v_exp_f32 v50, v50
    v_exp_f32 v51, v51
    v_exp_f32 v52, v52
    v_exp_f32 v53, v53
    v_exp_f32 v54, v54
    v_exp_f32 v55, v55
    s_setprio 0
    v_exp_f32 v56, v56
    v_exp_f32 v57, v57
    v_smfmac_f32_32x32x32_bf16 v[24:39], v[156:159], v[48:55], v6
    v_exp_f32 v58, v58
    v_exp_f32 v59, v59
    v_exp_f32 v60, v60
    v_exp_f32 v61, v61
    v_exp_f32 v62, v62
    v_exp_f32 v63, v63
    v_exp_f32 v64, v64
    v_exp_f32 v65, v65
    v_smfmac_f32_32x32x32_bf16 v[24:39], v[160:163], v[56:63], v6
    v_exp_f32 v66, v66
    v_exp_f32 v67, v67
    v_exp_f32 v68, v68
    v_exp_f32 v69, v69
    v_exp_f32 v70, v70
    v_exp_f32 v71, v71
    s_nop 1
    v_smfmac_f32_32x32x32_bf16 v[24:39], v[164:167], v[64:71], v6
    s_nop 11
    ds_write_b128 v5, v[24:27]
    ds_write_b128 v5, v[28:31] offset:1024
    ds_write_b32 v1, v32 offset:10240
    s_waitcnt vmcnt(0) lgkmcnt(0)
    s_barrier
    s_lshr_b32 s6, s3, 2
    s_cmp_le_u32 s6, s56
    s_cbranch_scc1 L_a_nowq
    s_lshr_b32 s7, s4, 5
    s_and_b32 s7, s7, 7
    s_and_b32 s6, s4, 1
    s_add_u32 s7, s7, s6
    s_and_b32 s7, s7, 7
    s_lshl_b32 s7, s7, 16
    s_lshl_b32 s6, s3, 14
    s_add_u32 s6, s6, s7
    s_add_u32 s7, s6, 983040
    buffer_load_dwordx4 v[40:43], v4, s[36:39], s7 offen offset:0 sc1
    buffer_load_dwordx4 v[44:47], v4, s[36:39], s7 offen offset:1024 sc1
    buffer_load_dwordx4 v[48:51], v4, s[36:39], s7 offen offset:2048 sc1
    buffer_load_dwordx4 v[52:55], v4, s[36:39], s7 offen offset:3072 sc1
    s_add_u32 s7, s6, 987136
    buffer_load_dwordx4 v[56:59], v4, s[36:39], s7 offen offset:0 sc1
L_a_nowq:
    s_lshl_b32 s6, s3, 10
    v_add_u32 v25, s6, v4
    s_barrier
    ds_read_b32 v24, v2 offset:80
    ds_read_b128 v[16:19], v25 offset:20480
    s_waitcnt lgkmcnt(1)
    v_cmp_ne_u32 vcc, 0, v24
    s_cbranch_vccnz L_a_exact
L_a_rejoin:
    s_cmp_lg_u32 s56, 0
    s_cbranch_scc1 L_a_final
    s_add_u32 s58, s58, 131072
    s_add_u32 s64, s64, 131072
    s_add_u32 s65, s65, 131072
    s_add_u32 s66, s66, 131072
    s_add_u32 s67, s67, 131072
    s_cmp_ge_u32 s3, 2
    s_cbranch_scc1 L_a_nowkv
    v_add_u32 v26, s75, v4
    ds_read_b128 v[40:43], v26 offset:0
    ds_read_b128 v[44:47], v26 offset:1024
    ds_read_b128 v[48:51], v26 offset:2048
    ds_read_b128 v[52:55], v26 offset:3072
    ds_read_b128 v[56:59], v26 offset:4096
    ds_read_b128 v[60:63], v26 offset:5120
    ds_read_b128 v[64:67], v26 offset:6144
    ds_read_b128 v[68:71], v26 offset:7168
    ds_read_b128 v[72:75], v26 offset:8192
    ds_read_b128 v[76:79], v26 offset:9216
    ds_read_b128 v[80:83], v26 offset:10240
    ds_read_b128 v[84:87], v26 offset:11264
    ds_read_b128 v[88:91], v26 offset:12288
    ds_read_b128 v[92:95], v26 offset:13312
    ds_read_b128 v[96:99], v26 offset:14336
    ds_read_b128 v[100:103], v26 offset:15360
    s_setprio 3
L_a_nowkv:
    v_lshrrev_b32 v20, 4, v0
    v_lshlrev_b32 v20, 5, v20
    v_xor_b32 v20, v20, v4
    s_lshl_b32 s6, s3, 11
    v_lshl_add_u32 v27, v0, 3, s6
    s_cmp_lt_u32 s3, 4
    s_cbranch_scc1 L_a_nowq2
    s_lshr_b32 s7, s4, 5
    s_and_b32 s7, s7, 7
    s_and_b32 s6, s4, 1
    s_add_u32 s7, s7, s6
    s_and_b32 s7, s7, 7
    s_lshl_b32 s7, s7, 16
    s_lshl_b32 s6, s3, 14
    s_add_u32 s6, s6, s7
    s_add_u32 s7, s6, 987136
    s_waitcnt lgkmcnt(10)
    buffer_load_dwordx4 v[60:63], v4, s[36:39], s7 offen offset:1024 sc1
    s_waitcnt lgkmcnt(9)
    buffer_load_dwordx4 v[64:67], v4, s[36:39], s7 offen offset:2048 sc1
    s_waitcnt lgkmcnt(8)
    buffer_load_dwordx4 v[68:71], v4, s[36:39], s7 offen offset:3072 sc1
    s_add_u32 s7, s6, 991232
    s_waitcnt lgkmcnt(7)
    buffer_load_dwordx4 v[72:75], v4, s[36:39], s7 offen offset:0 sc1
    s_waitcnt lgkmcnt(6)
    buffer_load_dwordx4 v[76:79], v4, s[36:39], s7 offen offset:1024 sc1
    s_waitcnt lgkmcnt(5)
    buffer_load_dwordx4 v[80:83], v4, s[36:39], s7 offen offset:2048 sc1
L_a_nowq2:
    s_barrier
    ds_read_b64 v[32:33], v27 offset:28672
    ds_read_b64 v[34:35], v27 offset:29184
    ds_read_b64 v[36:37], v27 offset:29696
    ds_read_b64 v[38:39], v27 offset:30208
    s_waitcnt lgkmcnt(4)
    v_lshlrev_b32 v24, 16, v16
    v_and_b32 v25, 0xffff0000, v16
    v_lshlrev_b32 v26, 16, v17
    v_and_b32 v27, 0xffff0000, v17
    v_lshlrev_b32 v28, 16, v18
    v_and_b32 v29, 0xffff0000, v18
    v_lshlrev_b32 v30, 16, v19
    v_and_b32 v31, 0xffff0000, v19
    s_waitcnt lgkmcnt(3)
    v_pk_add_f32 v[8:9], v[8:9], v[32:33]
    s_waitcnt lgkmcnt(2)
    v_pk_add_f32 v[10:11], v[10:11], v[34:35]
    s_waitcnt lgkmcnt(1)
    v_pk_add_f32 v[12:13], v[12:13], v[36:37]
    s_waitcnt lgkmcnt(0)
    v_pk_add_f32 v[14:15], v[14:15], v[38:39]
    v_pk_add_f32 v[104:105], v[8:9], v[10:11]
    v_pk_fma_f32 v[106:107], v[8:9], v[8:9], s[86:87]
    v_pk_add_f32 v[112:113], v[12:13], v[14:15]
    v_pk_fma_f32 v[106:107], v[10:11], v[10:11], v[106:107]
    v_pk_add_f32 v[104:105], v[104:105], v[112:113]
    v_pk_fma_f32 v[106:107], v[12:13], v[12:13], v[106:107]
    v_add_f32 v104, v104, v105
    v_pk_fma_f32 v[106:107], v[14:15], v[14:15], v[106:107]
    v_add_f32 v106, v106, v107
    s_nop 1
    v_permlane32_swap_b32 v104, v106
    v_add_f32 v104, v104, v106
    s_nop 1
    v_add_f32_dpp v104, v104, v104 quad_perm:[1,0,3,2] row_mask:0xf bank_mask:0xf
    s_nop 1
    v_add_f32_dpp v104, v104, v104 quad_perm:[2,3,0,1] row_mask:0xf bank_mask:0xf
    s_nop 1
    v_add_f32_dpp v104, v104, v104 row_half_mirror row_mask:0xf bank_mask:0xf
    s_nop 1
    v_add_f32_dpp v104, v104, v104 row_mirror row_mask:0xf bank_mask:0xf
    s_nop 1
    v_add_f32_dpp v104, v104, v104 row_bcast:15 row_mask:0xa bank_mask:0xf
    v_mul_f32 v104, 0x3b000000, v104
    s_nop 0
    v_readlane_b32 s68, v104, 31
    v_readlane_b32 s69, v104, 63
    s_nop 0
    v_mov_b32 v107, s68
    v_fma_f32 v106, -v107, v107, s69
    v_max_f32 v106, 0x3727c5ac, v106
    v_rsq_f32 v106, v106
    s_nop 0
    v_mul_f32_e64 v107, -v107, v106
    v_pk_fma_f32 v[32:33], v[8:9], v[106:107], v[106:107] op_sel:[0,0,1] op_sel_hi:[1,0,1]
    v_pk_fma_f32 v[34:35], v[10:11], v[106:107], v[106:107] op_sel:[0,0,1] op_sel_hi:[1,0,1]
    v_pk_fma_f32 v[36:37], v[12:13], v[106:107], v[106:107] op_sel:[0,0,1] op_sel_hi:[1,0,1]
    v_pk_fma_f32 v[38:39], v[14:15], v[106:107], v[106:107] op_sel:[0,0,1] op_sel_hi:[1,0,1]
    v_pk_fma_f32 v[8:9], v[32:33], v[24:25], v[8:9]
    v_pk_fma_f32 v[10:11], v[34:35], v[26:27], v[10:11]
    v_pk_fma_f32 v[12:13], v[36:37], v[28:29], v[12:13]
    v_pk_fma_f32 v[14:15], v[38:39], v[30:31], v[14:15]
    s_mov_b32 s56, 1
    v_pk_add_f32 v[104:105], v[8:9], v[10:11]
    v_pk_fma_f32 v[106:107], v[8:9], v[8:9], s[86:87]
    v_pk_add_f32 v[112:113], v[12:13], v[14:15]
    v_pk_fma_f32 v[106:107], v[10:11], v[10:11], v[106:107]
    v_pk_add_f32 v[104:105], v[104:105], v[112:113]
    v_pk_fma_f32 v[106:107], v[12:13], v[12:13], v[106:107]
    v_add_f32 v104, v104, v105
    v_pk_fma_f32 v[106:107], v[14:15], v[14:15], v[106:107]
    v_add_f32 v106, v106, v107
    s_nop 1
    v_permlane32_swap_b32 v104, v106
    v_add_f32 v104, v104, v106
    s_nop 1
    v_add_f32_dpp v104, v104, v104 quad_perm:[1,0,3,2] row_mask:0xf bank_mask:0xf
    s_nop 1
    v_add_f32_dpp v104, v104, v104 quad_perm:[2,3,0,1] row_mask:0xf bank_mask:0xf
    s_nop 1
    v_add_f32_dpp v104, v104, v104 row_half_mirror row_mask:0xf bank_mask:0xf
    s_nop 1
    v_add_f32_dpp v104, v104, v104 row_mirror row_mask:0xf bank_mask:0xf
    s_nop 1
    v_add_f32_dpp v104, v104, v104 row_bcast:15 row_mask:0xa bank_mask:0xf
    v_mul_f32 v104, 0x3b000000, v104
    s_nop 0
    v_readlane_b32 s68, v104, 31
    v_readlane_b32 s69, v104, 63
    s_nop 0
    v_mov_b32 v107, s68
    v_fma_f32 v106, -v107, v107, s69
    v_max_f32 v106, 0x3727c5ac, v106
    v_rsq_f32 v106, v106
    s_nop 0
    v_mul_f32_e64 v107, -v107, v106
    v_pk_fma_f32 v[24:25], v[8:9], v[106:107], v[106:107] op_sel:[0,0,1] op_sel_hi:[1,0,1]
    v_pk_fma_f32 v[26:27], v[10:11], v[106:107], v[106:107] op_sel:[0,0,1] op_sel_hi:[1,0,1]
    v_pk_fma_f32 v[28:29], v[12:13], v[106:107], v[106:107] op_sel:[0,0,1] op_sel_hi:[1,0,1]
    v_pk_fma_f32 v[30:31], v[14:15], v[106:107], v[106:107] op_sel:[0,0,1] op_sel_hi:[1,0,1]
    v_cvt_pk_bf16_f32 v16, v24, v25
    v_cvt_pk_bf16_f32 v17, v26, v27
    v_cvt_pk_bf16_f32 v18, v28, v29
    v_cvt_pk_bf16_f32 v19, v30, v31
    ds_write_b128 v7, v[16:19] offset:12288
    s_waitcnt lgkmcnt(0)
    s_barrier
    s_cmp_ge_u32 s3, 2
    s_cbranch_scc1 L_a_m2
    ds_read_b128 v[104:107], v20 offset:12288
    ds_read_b128 v[112:115], v20 offset:13312
    ds_read_b128 v[120:123], v20 offset:14336
    ds_read_b128 v[128:131], v20 offset:15360
    ds_read_b128 v[136:139], v20 offset:16384
    ds_read_b128 v[144:147], v20 offset:17408
    ds_read_b128 v[152:155], v20 offset:18432
    ds_read_b128 v[160:163], v20 offset:19456
    v_and_b32 v32, 1, v0
    v_mul_u32_u24 v32, 0xaaaa, v32
    v_add_u32 v32, 0x4444, v32
    v_mov_b64 v[24:25], 0
    v_mov_b64 v[26:27], 0
    s_lshl_b32 s6, s3, 8
    v_add_u32 v30, s6, v4
    v_and_b32 v28, 0x80, v4
    v_add_u32 v28, s6, v28
    v_and_b32 v29, 7, v0
    v_mad_u32_u24 v28, v29, s72, v28
    v_lshrrev_b32 v29, 4, v0
    v_mad_u32_u24 v28, v29, s73, v28
    v_add_u32 v29, s74, v28
    s_waitcnt lgkmcnt(7)
    v_smfmac_f32_16x16x64_bf16 v[24:27], v[104:107], v[40:47], v32
    s_waitcnt lgkmcnt(6)
    v_smfmac_f32_16x16x64_bf16 v[24:27], v[112:115], v[48:55], v32
    s_waitcnt lgkmcnt(5)
    v_smfmac_f32_16x16x64_bf16 v[24:27], v[120:123], v[56:63], v32
    s_waitcnt lgkmcnt(4)
    v_smfmac_f32_16x16x64_bf16 v[24:27], v[128:131], v[64:71], v32
    s_waitcnt lgkmcnt(3)
    v_smfmac_f32_16x16x64_bf16 v[24:27], v[136:139], v[72:79], v32
    s_waitcnt lgkmcnt(2)
    v_smfmac_f32_16x16x64_bf16 v[24:27], v[144:147], v[80:87], v32
    s_waitcnt lgkmcnt(1)
    v_smfmac_f32_16x16x64_bf16 v[24:27], v[152:155], v[88:95], v32
    s_waitcnt lgkmcnt(0)
    v_smfmac_f32_16x16x64_bf16 v[24:27], v[160:163], v[96:103], v32
    s_nop 7
    v_add_f32 v24, v24, v25
    v_add_f32 v26, v26, v27
    v_mul_f32 v24, s59, v24
    v_mul_f32 v26, s59, v26
    v_cvt_pk_bf16_f32 v24, v24, v26
    ds_write_b16 v28, v24 offset:256
    ds_write_b16_d16_hi v29, v24 offset:256
    s_mov_b64 exec, 0xffff
    ds_read_b128 v[24:27], v30 offset:256
    s_waitcnt lgkmcnt(0)
    buffer_store_dwordx4 v[24:27], v4, s[36:39], s58 offen sc1
    s_mov_b64 exec, -1
    s_add_u32 s6, s70, 8650752
    buffer_store_dwordx4 v[16:19], v4, s[36:39], s6 offen sc1
    v_and_b32 v28, 11, v0
    v_cmp_eq_u32 vcc, 0, v28
    v_mov_b32 v28, 0x3f803f80
    s_nop 0
    v_cndmask_b32 v108, 0, v28, vcc
    v_mov_b32 v109, v108
    v_mov_b64 v[110:111], v[108:109]
    v_mov_b64 v[116:117], v[108:109]
    v_mov_b64 v[118:119], v[108:109]
    v_mov_b64 v[124:125], v[108:109]
    v_mov_b64 v[126:127], v[108:109]
    v_mov_b64 v[132:133], v[108:109]
    v_mov_b64 v[134:135], v[108:109]
    v_mov_b64 v[140:141], v[108:109]
    v_mov_b64 v[142:143], v[108:109]
    v_mov_b64 v[148:149], v[108:109]
    v_mov_b64 v[150:151], v[108:109]
    v_mov_b64 v[156:157], v[108:109]
    v_mov_b64 v[158:159], v[108:109]
    v_mov_b64 v[164:165], v[108:109]
    v_mov_b64 v[166:167], v[108:109]
    s_mov_b32 s57, 20000
    s_barrier
    s_branch L_a_ld
L_a_m2:
    s_cmp_ge_u32 s3, 4
    s_cbranch_scc1 L_a_m4
    v_and_b32 v24, 11, v0
    v_cmp_eq_u32 vcc, 0, v24
    v_mov_b32 v24, 0x3f803f80
    s_nop 0
    v_cndmask_b32 v108, 0, v24, vcc
    v_mov_b32 v109, v108
    v_mov_b64 v[110:111], v[108:109]
    v_mov_b64 v[116:117], v[108:109]
    v_mov_b64 v[118:119], v[108:109]
    v_mov_b64 v[124:125], v[108:109]
    v_mov_b64 v[126:127], v[108:109]
    v_mov_b64 v[132:133], v[108:109]
    v_mov_b64 v[134:135], v[108:109]
    v_mov_b64 v[140:141], v[108:109]
    v_mov_b64 v[142:143], v[108:109]
    v_mov_b64 v[148:149], v[108:109]
    v_mov_b64 v[150:151], v[108:109]
    v_mov_b64 v[156:157], v[108:109]
    v_mov_b64 v[158:159], v[108:109]
    v_mov_b64 v[164:165], v[108:109]
    v_mov_b64 v[166:167], v[108:109]
    s_mov_b32 s57, 20000
    s_add_u32 s6, s70, 8650752
    buffer_store_dwordx4 v[16:19], v4, s[36:39], s6 offen sc1
    s_barrier
    s_branch L_a_ld
L_a_m4:
    s_lshr_b32 s7, s4, 5
    s_and_b32 s7, s7, 7
    s_and_b32 s6, s4, 1
    s_add_u32 s7, s7, s6
    s_and_b32 s7, s7, 7
    s_lshl_b32 s7, s7, 16
    s_lshl_b32 s6, s3, 14
    s_add_u32 s6, s6, s7
    s_add_u32 s7, s6, 991232
    buffer_load_dwordx4 v[84:87], v4, s[36:39], s7 offen offset:3072 sc1
    s_add_u32 s7, s6, 995328
    buffer_load_dwordx4 v[88:91], v4, s[36:39], s7 offen offset:0 sc1
    buffer_load_dwordx4 v[92:95], v4, s[36:39], s7 offen offset:1024 sc1
    buffer_load_dwordx4 v[96:99], v4, s[36:39], s7 offen offset:2048 sc1
    buffer_load_dwordx4 v[100:103], v4, s[36:39], s7 offen offset:3072 sc1
    v_and_b32 v24, 11, v0
    v_cmp_eq_u32 vcc, 0, v24
    v_mov_b32 v24, 0x3f803f80
    s_nop 0
    v_cndmask_b32 v108, 0, v24, vcc
    v_mov_b32 v109, v108
    v_mov_b64 v[110:111], v[108:109]
    v_mov_b64 v[116:117], v[108:109]
    v_mov_b64 v[118:119], v[108:109]
    v_mov_b64 v[124:125], v[108:109]
    v_mov_b64 v[126:127], v[108:109]
    v_mov_b64 v[132:133], v[108:109]
    v_mov_b64 v[134:135], v[108:109]
    v_mov_b64 v[140:141], v[108:109]
    v_mov_b64 v[142:143], v[108:109]
    v_mov_b64 v[148:149], v[108:109]
    v_mov_b64 v[150:151], v[108:109]
    v_mov_b64 v[156:157], v[108:109]
    v_mov_b64 v[158:159], v[108:109]
    v_mov_b64 v[164:165], v[108:109]
    v_mov_b64 v[166:167], v[108:109]
    s_mov_b32 s57, 20000
    s_waitcnt vmcnt(5)
    ds_read_b128 v[104:107], v20 offset:12288
    ds_read_b128 v[112:115], v20 offset:13312
    ds_read_b128 v[120:123], v20 offset:14336
    ds_read_b128 v[128:131], v20 offset:15360
    ds_read_b128 v[136:139], v20 offset:16384
    ds_read_b128 v[144:147], v20 offset:17408
    ds_read_b128 v[152:155], v20 offset:18432
    ds_read_b128 v[160:163], v20 offset:19456
    v_and_b32 v32, 1, v0
    v_mul_u32_u24 v32, 0xaaaa, v32
    v_add_u32 v32, 0x4444, v32
    v_mov_b64 v[24:25], 0
    v_mov_b64 v[26:27], 0
    v_and_b32 v28, 0x80, v4
    v_lshlrev_b32 v28, 2, v28
    v_lshrrev_b32 v29, 4, v0
    v_lshl_add_u32 v28, v29, 5, v28
    v_and_b32 v29, 7, v0
    v_lshl_add_u32 v28, v29, 1, v28
    s_lshl_b32 s6, s3, 7
    v_add_u32 v28, s6, v28
    s_waitcnt lgkmcnt(7)
    v_smfmac_f32_16x16x64_bf16 v[24:27], v[104:107], v[40:47], v32
    s_waitcnt lgkmcnt(6)
    v_smfmac_f32_16x16x64_bf16 v[24:27], v[112:115], v[48:55], v32
    s_waitcnt lgkmcnt(5)
    v_smfmac_f32_16x16x64_bf16 v[24:27], v[120:123], v[56:63], v32
    s_waitcnt lgkmcnt(4)
    v_smfmac_f32_16x16x64_bf16 v[24:27], v[128:131], v[64:71], v32
    s_waitcnt lgkmcnt(3)
    v_smfmac_f32_16x16x64_bf16 v[24:27], v[136:139], v[72:79], v32
    s_waitcnt lgkmcnt(2) vmcnt(4)
    v_smfmac_f32_16x16x64_bf16 v[24:27], v[144:147], v[80:87], v32
    s_waitcnt vmcnt(2) lgkmcnt(1)
    v_smfmac_f32_16x16x64_bf16 v[24:27], v[152:155], v[88:95], v32
    s_waitcnt vmcnt(0) lgkmcnt(0)
    v_smfmac_f32_16x16x64_bf16 v[24:27], v[160:163], v[96:103], v32
    s_nop 7
    v_add_f32 v24, v24, v25
    v_add_f32 v26, v26, v27
    v_cvt_pk_bf16_f32 v24, v24, v26
    ds_write_b16 v28, v24 offset:512
    ds_write_b16_d16_hi v28, v24 offset:528
    s_add_u32 s6, s70, 8650752
    buffer_store_dwordx4 v[16:19], v4, s[36:39], s6 offen sc1
    s_waitcnt lgkmcnt(0)
    s_barrier
    s_branch L_a_ld
L_a_final:
    s_mov_b32 s40, s30
    s_mov_b32 s41, s31
    s_mov_b32 s42, 2097152
    s_mov_b32 s43, 0x20000
    s_lshl_b32 s6, s3, 11
    v_lshl_add_u32 v27, v0, 3, s6
    s_barrier
    ds_read_b64 v[32:33], v27 offset:28672
    ds_read_b64 v[34:35], v27 offset:29184
    ds_read_b64 v[36:37], v27 offset:29696
    ds_read_b64 v[38:39], v27 offset:30208
    s_waitcnt lgkmcnt(4)
    v_lshlrev_b32 v24, 16, v16
    v_and_b32 v25, 0xffff0000, v16
    v_lshlrev_b32 v26, 16, v17
    v_and_b32 v27, 0xffff0000, v17
    v_lshlrev_b32 v28, 16, v18
    v_and_b32 v29, 0xffff0000, v18
    v_lshlrev_b32 v30, 16, v19
    v_and_b32 v31, 0xffff0000, v19
    s_waitcnt lgkmcnt(3)
    v_pk_add_f32 v[8:9], v[8:9], v[32:33]
    s_waitcnt lgkmcnt(2)
    v_pk_add_f32 v[10:11], v[10:11], v[34:35]
    s_waitcnt lgkmcnt(1)
    v_pk_add_f32 v[12:13], v[12:13], v[36:37]
    s_waitcnt lgkmcnt(0)
    v_pk_add_f32 v[14:15], v[14:15], v[38:39]
    v_pk_add_f32 v[104:105], v[8:9], v[10:11]
    v_pk_fma_f32 v[106:107], v[8:9], v[8:9], s[86:87]
    v_pk_add_f32 v[112:113], v[12:13], v[14:15]
    v_pk_fma_f32 v[106:107], v[10:11], v[10:11], v[106:107]
    v_pk_add_f32 v[104:105], v[104:105], v[112:113]
    v_pk_fma_f32 v[106:107], v[12:13], v[12:13], v[106:107]
    v_add_f32 v104, v104, v105
    v_pk_fma_f32 v[106:107], v[14:15], v[14:15], v[106:107]
    v_add_f32 v106, v106, v107
    s_nop 1
    v_permlane32_swap_b32 v104, v106
    v_add_f32 v104, v104, v106
    s_nop 1
    v_add_f32_dpp v104, v104, v104 quad_perm:[1,0,3,2] row_mask:0xf bank_mask:0xf
    s_nop 1
    v_add_f32_dpp v104, v104, v104 quad_perm:[2,3,0,1] row_mask:0xf bank_mask:0xf
    s_nop 1
    v_add_f32_dpp v104, v104, v104 row_half_mirror row_mask:0xf bank_mask:0xf
    s_nop 1
    v_add_f32_dpp v104, v104, v104 row_mirror row_mask:0xf bank_mask:0xf
    s_nop 1
    v_add_f32_dpp v104, v104, v104 row_bcast:15 row_mask:0xa bank_mask:0xf
    v_mul_f32 v104, 0x3b000000, v104
    s_nop 0
    v_readlane_b32 s68, v104, 31
    v_readlane_b32 s69, v104, 63
    s_nop 0
    v_mov_b32 v107, s68
    v_fma_f32 v106, -v107, v107, s69
    v_max_f32 v106, 0x3727c5ac, v106
    v_rsq_f32 v106, v106
    s_nop 0
    v_mul_f32_e64 v107, -v107, v106
    v_pk_fma_f32 v[32:33], v[8:9], v[106:107], v[106:107] op_sel:[0,0,1] op_sel_hi:[1,0,1]
    v_pk_fma_f32 v[34:35], v[10:11], v[106:107], v[106:107] op_sel:[0,0,1] op_sel_hi:[1,0,1]
    v_pk_fma_f32 v[36:37], v[12:13], v[106:107], v[106:107] op_sel:[0,0,1] op_sel_hi:[1,0,1]
    v_pk_fma_f32 v[38:39], v[14:15], v[106:107], v[106:107] op_sel:[0,0,1] op_sel_hi:[1,0,1]
    v_pk_fma_f32 v[8:9], v[32:33], v[24:25], v[8:9]
    v_pk_fma_f32 v[10:11], v[34:35], v[26:27], v[10:11]
    v_pk_fma_f32 v[12:13], v[36:37], v[28:29], v[12:13]
    v_pk_fma_f32 v[14:15], v[38:39], v[30:31], v[14:15]
    v_cvt_pk_bf16_f32 v16, v8, v9
    v_cvt_pk_bf16_f32 v17, v10, v11
    v_cvt_pk_bf16_f32 v18, v12, v13
    v_cvt_pk_bf16_f32 v19, v14, v15
    buffer_store_dwordx4 v[16:19], v4, s[40:43], s70 offen
    s_endpgm
L_a_q0w:
    s_sleep 1
    s_branch L_a_q0
L_a_retry0:
    s_sub_u32 s57, s57, 1
    s_cmp_lt_i32 s57, 0
    s_cbranch_scc1 L_a_back0
    s_sleep 4
    buffer_load_dwordx4 v[72:75], v21, s[36:39], s64 offen offset:0 sc1
    buffer_load_dwordx4 v[104:107], v22, s[36:39], s64 offen offset:0 sc1
    buffer_load_dwordx4 v[76:79], v21, s[36:39], s64 offen offset:2048 sc1
    buffer_load_dwordx4 v[112:115], v22, s[36:39], s64 offen offset:2048 sc1
    buffer_load_dwordx4 v[80:83], v21, s[36:39], s65 offen offset:0 sc1
    buffer_load_dwordx4 v[120:123], v22, s[36:39], s65 offen offset:0 sc1
    s_waitcnt vmcnt(4)
    v_max_u32 v20, v72, v104
    v_cmp_eq_u32 vcc, -1, v20
    s_cbranch_vccnz L_a_retry0
    s_branch L_a_back0
L_a_tag:
    v_mov_b32 v56, s5
    v_mov_b32 v57, s5
    v_mov_b32 v58, s5
    v_mov_b32 v59, s5
    s_mov_b64 exec, 3
    buffer_store_dwordx4 v[56:59], v4, s[36:39], s79 offen sc1
    s_mov_b64 exec, -1
    s_branch L_a_tagged
L_a_retry1:
    s_sub_u32 s57, s57, 1
    s_cmp_lt_i32 s57, 0
    s_cbranch_scc1 L_a_back1
    s_sleep 4
    buffer_load_dwordx4 v[76:79], v21, s[36:39], s64 offen offset:2048 sc1
    buffer_load_dwordx4 v[112:115], v22, s[36:39], s64 offen offset:2048 sc1
    buffer_load_dwordx4 v[80:83], v21, s[36:39], s65 offen offset:0 sc1
    buffer_load_dwordx4 v[120:123], v22, s[36:39], s65 offen offset:0 sc1
    buffer_load_dwordx4 v[84:87], v21, s[36:39], s65 offen offset:2048 sc1
    buffer_load_dwordx4 v[128:131], v22, s[36:39], s65 offen offset:2048 sc1
    s_waitcnt vmcnt(4)
    v_max_u32 v20, v76, v112
    v_cmp_eq_u32 vcc, -1, v20
    s_cbranch_vccnz L_a_retry1
    s_branch L_a_back1
L_a_retry2:
    s_sub_u32 s57, s57, 1
    s_cmp_lt_i32 s57, 0
    s_cbranch_scc1 L_a_back2
    s_sleep 4
    buffer_load_dwordx4 v[80:83], v21, s[36:39], s65 offen offset:0 sc1
    buffer_load_dwordx4 v[120:123], v22, s[36:39], s65 offen offset:0 sc1
    buffer_load_dwordx4 v[84:87], v21, s[36:39], s65 offen offset:2048 sc1
    buffer_load_dwordx4 v[128:131], v22, s[36:39], s65 offen offset:2048 sc1
    buffer_load_dwordx4 v[88:91], v21, s[36:39], s66 offen offset:0 sc1
    buffer_load_dwordx4 v[136:139], v22, s[36:39], s66 offen offset:0 sc1
    s_waitcnt vmcnt(4)
    v_max_u32 v20, v80, v120
    v_cmp_eq_u32 vcc, -1, v20
    s_cbranch_vccnz L_a_retry2
    s_branch L_a_back2
L_a_retry3:
    s_sub_u32 s57, s57, 1
    s_cmp_lt_i32 s57, 0
    s_cbranch_scc1 L_a_back3
    s_sleep 4
    buffer_load_dwordx4 v[84:87], v21, s[36:39], s65 offen offset:2048 sc1
    buffer_load_dwordx4 v[128:131], v22, s[36:39], s65 offen offset:2048 sc1
    buffer_load_dwordx4 v[88:91], v21, s[36:39], s66 offen offset:0 sc1
    buffer_load_dwordx4 v[136:139], v22, s[36:39], s66 offen offset:0 sc1
    buffer_load_dwordx4 v[92:95], v21, s[36:39], s66 offen offset:2048 sc1
    buffer_load_dwordx4 v[144:147], v22, s[36:39], s66 offen offset:2048 sc1
    s_waitcnt vmcnt(4)
    v_max_u32 v20, v84, v128
    v_cmp_eq_u32 vcc, -1, v20
    s_cbranch_vccnz L_a_retry3
    s_branch L_a_back3
L_a_retry4:
    s_sub_u32 s57, s57, 1
    s_cmp_lt_i32 s57, 0
    s_cbranch_scc1 L_a_back4
    s_sleep 4
    buffer_load_dwordx4 v[88:91], v21, s[36:39], s66 offen offset:0 sc1
    buffer_load_dwordx4 v[136:139], v22, s[36:39], s66 offen offset:0 sc1
    buffer_load_dwordx4 v[92:95], v21, s[36:39], s66 offen offset:2048 sc1
    buffer_load_dwordx4 v[144:147], v22, s[36:39], s66 offen offset:2048 sc1
    buffer_load_dwordx4 v[96:99], v21, s[36:39], s67 offen offset:0 sc1
    buffer_load_dwordx4 v[152:155], v22, s[36:39], s67 offen offset:0 sc1
    s_waitcnt vmcnt(4)
    v_max_u32 v20, v88, v136
    v_cmp_eq_u32 vcc, -1, v20
    s_cbranch_vccnz L_a_retry4
    s_branch L_a_back4
L_a_retry5:
    s_sub_u32 s57, s57, 1
    s_cmp_lt_i32 s57, 0
    s_cbranch_scc1 L_a_back5
    s_sleep 4
    buffer_load_dwordx4 v[92:95], v21, s[36:39], s66 offen offset:2048 sc1
    buffer_load_dwordx4 v[144:147], v22, s[36:39], s66 offen offset:2048 sc1
    buffer_load_dwordx4 v[96:99], v21, s[36:39], s67 offen offset:0 sc1
    buffer_load_dwordx4 v[152:155], v22, s[36:39], s67 offen offset:0 sc1
    buffer_load_dwordx4 v[100:103], v21, s[36:39], s67 offen offset:2048 sc1
    buffer_load_dwordx4 v[160:163], v22, s[36:39], s67 offen offset:2048 sc1
    s_waitcnt vmcnt(4)
    v_max_u32 v20, v92, v144
    v_cmp_eq_u32 vcc, -1, v20
    s_cbranch_vccnz L_a_retry5
    s_branch L_a_back5
L_a_retry6:
    s_sub_u32 s57, s57, 1
    s_cmp_lt_i32 s57, 0
    s_cbranch_scc1 L_a_back6
    s_sleep 4
    buffer_load_dwordx4 v[96:99], v21, s[36:39], s67 offen offset:0 sc1
    buffer_load_dwordx4 v[152:155], v22, s[36:39], s67 offen offset:0 sc1
    buffer_load_dwordx4 v[100:103], v21, s[36:39], s67 offen offset:2048 sc1
    buffer_load_dwordx4 v[160:163], v22, s[36:39], s67 offen offset:2048 sc1
    s_waitcnt vmcnt(2)
    v_max_u32 v20, v96, v152
    v_cmp_eq_u32 vcc, -1, v20
    s_cbranch_vccnz L_a_retry6
    s_branch L_a_back6
L_a_retry7:
    s_sub_u32 s57, s57, 1
    s_cmp_lt_i32 s57, 0
    s_cbranch_scc1 L_a_back7
    s_sleep 4
    buffer_load_dwordx4 v[100:103], v21, s[36:39], s67 offen offset:2048 sc1
    buffer_load_dwordx4 v[160:163], v22, s[36:39], s67 offen offset:2048 sc1
    s_waitcnt vmcnt(0)
    v_max_u32 v20, v100, v160
    v_cmp_eq_u32 vcc, -1, v20
    s_cbranch_vccnz L_a_retry7
    s_branch L_a_back7
L_a_exact:
    s_waitcnt vmcnt(0) lgkmcnt(0)
    v_and_b32 v20, 11, v0
    v_cmp_eq_u32 vcc, 0, v20
    v_mov_b32 v20, 0x3f803f80
    s_nop 0
    v_cndmask_b32 v108, 0, v20, vcc
    v_mov_b32 v109, v108
    v_mov_b64 v[110:111], v[108:109]
    v_mov_b64 v[116:117], v[108:109]
    v_mov_b64 v[118:119], v[108:109]
    v_mov_b64 v[124:125], v[108:109]
    v_mov_b64 v[126:127], v[108:109]
    v_mov_b64 v[132:133], v[108:109]
    v_mov_b64 v[134:135], v[108:109]
    v_mov_b64 v[140:141], v[108:109]
    v_mov_b64 v[142:143], v[108:109]
    v_mov_b64 v[148:149], v[108:109]
    v_mov_b64 v[150:151], v[108:109]
    v_mov_b64 v[156:157], v[108:109]
    v_mov_b64 v[158:159], v[108:109]
    v_mov_b64 v[164:165], v[108:109]
    v_mov_b64 v[166:167], v[108:109]
    s_mov_b32 s57, 20000
    buffer_load_dwordx4 v[72:75], v21, s[36:39], s64 offen offset:0 sc1
    buffer_load_dwordx4 v[104:107], v22, s[36:39], s64 offen offset:0 sc1
    buffer_load_dwordx4 v[76:79], v21, s[36:39], s64 offen offset:2048 sc1
    buffer_load_dwordx4 v[112:115], v22, s[36:39], s64 offen offset:2048 sc1
    buffer_load_dwordx4 v[80:83], v21, s[36:39], s65 offen offset:0 sc1
    buffer_load_dwordx4 v[120:123], v22, s[36:39], s65 offen offset:0 sc1
    buffer_load_dwordx4 v[84:87], v21, s[36:39], s65 offen offset:2048 sc1
    buffer_load_dwordx4 v[128:131], v22, s[36:39], s65 offen offset:2048 sc1
    buffer_load_dwordx4 v[88:91], v21, s[36:39], s66 offen offset:0 sc1
    buffer_load_dwordx4 v[136:139], v22, s[36:39], s66 offen offset:0 sc1
    buffer_load_dwordx4 v[92:95], v21, s[36:39], s66 offen offset:2048 sc1
    buffer_load_dwordx4 v[144:147], v22, s[36:39], s66 offen offset:2048 sc1
    buffer_load_dwordx4 v[96:99], v21, s[36:39], s67 offen offset:0 sc1
    buffer_load_dwordx4 v[152:155], v22, s[36:39], s67 offen offset:0 sc1
    buffer_load_dwordx4 v[100:103], v21, s[36:39], s67 offen offset:2048 sc1
    buffer_load_dwordx4 v[160:163], v22, s[36:39], s67 offen offset:2048 sc1
    s_waitcnt vmcnt(0) lgkmcnt(0)
    v_permlane16_swap_b32 v104, v108
    v_permlane16_swap_b32 v105, v109
    v_permlane16_swap_b32 v106, v110
    v_permlane16_swap_b32 v107, v111
    v_permlane16_swap_b32 v112, v116
    v_permlane16_swap_b32 v113, v117
    v_permlane16_swap_b32 v114, v118
    v_permlane16_swap_b32 v115, v119
    v_permlane16_swap_b32 v120, v124
    v_permlane16_swap_b32 v121, v125
    v_permlane16_swap_b32 v122, v126
    v_permlane16_swap_b32 v123, v127
    v_permlane16_swap_b32 v128, v132
    v_permlane16_swap_b32 v129, v133
    v_permlane16_swap_b32 v130, v134
    v_permlane16_swap_b32 v131, v135
    v_permlane16_swap_b32 v136, v140
    v_permlane16_swap_b32 v137, v141
    v_permlane16_swap_b32 v138, v142
    v_permlane16_swap_b32 v139, v143
    v_permlane16_swap_b32 v144, v148
    v_permlane16_swap_b32 v145, v149
    v_permlane16_swap_b32 v146, v150
    v_permlane16_swap_b32 v147, v151
    v_permlane16_swap_b32 v152, v156
    v_permlane16_swap_b32 v153, v157
    v_permlane16_swap_b32 v154, v158
    v_permlane16_swap_b32 v155, v159
    v_permlane16_swap_b32 v160, v164
    v_permlane16_swap_b32 v161, v165
    v_permlane16_swap_b32 v162, v166
    v_permlane16_swap_b32 v163, v167
    s_mov_b32 s60, 1024
L_a_ex0:
    v_add_u32 v20, s60, v4
    ds_read_b128 v[16:19], v20
    v_mov_b32 v20, 0xff800000
    s_waitcnt lgkmcnt(0)
    v_mfma_f32_32x32x16_bf16 v[40:55], v[72:75], v[16:19], 0
    s_nop 11
    v_max3_f32 v20, v20, v40, v41
    v_max3_f32 v20, v20, v42, v43
    v_max3_f32 v20, v20, v44, v45
    v_max3_f32 v20, v20, v46, v47
    v_max3_f32 v20, v20, v48, v49
    v_max3_f32 v20, v20, v50, v51
    v_max3_f32 v20, v20, v52, v53
    v_max3_f32 v20, v20, v54, v55
    v_mfma_f32_32x32x16_bf16 v[40:55], v[76:79], v[16:19], 0
    s_nop 11
    v_max3_f32 v20, v20, v40, v41
    v_max3_f32 v20, v20, v42, v43
    v_max3_f32 v20, v20, v44, v45
    v_max3_f32 v20, v20, v46, v47
    v_max3_f32 v20, v20, v48, v49
    v_max3_f32 v20, v20, v50, v51
    v_max3_f32 v20, v20, v52, v53
    v_max3_f32 v20, v20, v54, v55
    v_mfma_f32_32x32x16_bf16 v[40:55], v[80:83], v[16:19], 0
    s_nop 11
    v_max3_f32 v20, v20, v40, v41
    v_max3_f32 v20, v20, v42, v43
    v_max3_f32 v20, v20, v44, v45
    v_max3_f32 v20, v20, v46, v47
    v_max3_f32 v20, v20, v48, v49
    v_max3_f32 v20, v20, v50, v51
    v_max3_f32 v20, v20, v52, v53
    v_max3_f32 v20, v20, v54, v55
    v_mfma_f32_32x32x16_bf16 v[40:55], v[84:87], v[16:19], 0
    s_nop 11
    v_max3_f32 v20, v20, v40, v41
    v_max3_f32 v20, v20, v42, v43
    v_max3_f32 v20, v20, v44, v45
    v_max3_f32 v20, v20, v46, v47
    v_max3_f32 v20, v20, v48, v49
    v_max3_f32 v20, v20, v50, v51
    v_max3_f32 v20, v20, v52, v53
    v_max3_f32 v20, v20, v54, v55
    v_mfma_f32_32x32x16_bf16 v[40:55], v[88:91], v[16:19], 0
    s_nop 11
    v_max3_f32 v20, v20, v40, v41
    v_max3_f32 v20, v20, v42, v43
    v_max3_f32 v20, v20, v44, v45
    v_max3_f32 v20, v20, v46, v47
    v_max3_f32 v20, v20, v48, v49
    v_max3_f32 v20, v20, v50, v51
    v_max3_f32 v20, v20, v52, v53
    v_max3_f32 v20, v20, v54, v55
    v_mfma_f32_32x32x16_bf16 v[40:55], v[92:95], v[16:19], 0
    s_nop 11
    v_max3_f32 v20, v20, v40, v41
    v_max3_f32 v20, v20, v42, v43
    v_max3_f32 v20, v20, v44, v45
    v_max3_f32 v20, v20, v46, v47
    v_max3_f32 v20, v20, v48, v49
    v_max3_f32 v20, v20, v50, v51
    v_max3_f32 v20, v20, v52, v53
    v_max3_f32 v20, v20, v54, v55
    v_mfma_f32_32x32x16_bf16 v[40:55], v[96:99], v[16:19], 0
    s_nop 11
    v_max3_f32 v20, v20, v40, v41
    v_max3_f32 v20, v20, v42, v43
    v_max3_f32 v20, v20, v44, v45
    v_max3_f32 v20, v20, v46, v47
    v_max3_f32 v20, v20, v48, v49
    v_max3_f32 v20, v20, v50, v51
    v_max3_f32 v20, v20, v52, v53
    v_max3_f32 v20, v20, v54, v55
    v_mfma_f32_32x32x16_bf16 v[40:55], v[100:103], v[16:19], 0
    s_nop 11
    v_max3_f32 v20, v20, v40, v41
    v_max3_f32 v20, v20, v42, v43
    v_max3_f32 v20, v20, v44, v45
    v_max3_f32 v20, v20, v46, v47
    v_max3_f32 v20, v20, v48, v49
    v_max3_f32 v20, v20, v50, v51
    v_max3_f32 v20, v20, v52, v53
    v_max3_f32 v20, v20, v54, v55
    v_mov_b32 v40, v20
    s_nop 1
    v_permlane32_swap_b32 v20, v40
    v_max_f32 v20, v20, v40
    ds_write_b32 v1, v20 offset:11264
    s_waitcnt lgkmcnt(0)
    s_barrier
    v_and_b32 v20, 0x1f0, v4
    ds_read_b128 v[40:43], v20 offset:11264
    ds_read_b128 v[44:47], v20 offset:11776
    s_waitcnt lgkmcnt(1)
    v_max3_f32 v20, v40, v41, v42
    s_waitcnt lgkmcnt(0)
    v_max3_f32 v20, v20, v43, v44
    v_max3_f32 v20, v20, v45, v46
    v_max_f32 v20, v20, v47
    v_xor_b32 v56, 0x80000000, v20
    v_xor_b32 v57, 0x80000000, v20
    v_xor_b32 v58, 0x80000000, v20
    v_xor_b32 v59, 0x80000000, v20
    v_xor_b32 v60, 0x80000000, v20
    v_xor_b32 v61, 0x80000000, v20
    v_xor_b32 v62, 0x80000000, v20
    v_xor_b32 v63, 0x80000000, v20
    v_xor_b32 v64, 0x80000000, v20
    v_xor_b32 v65, 0x80000000, v20
    v_xor_b32 v66, 0x80000000, v20
    v_xor_b32 v67, 0x80000000, v20
    v_xor_b32 v68, 0x80000000, v20
    v_xor_b32 v69, 0x80000000, v20
    v_xor_b32 v70, 0x80000000, v20
    v_xor_b32 v71, 0x80000000, v20
    v_mov_b64 v[24:25], 0
    v_mov_b64 v[26:27], 0
    v_mov_b64 v[28:29], 0
    v_mov_b64 v[30:31], 0
    v_mov_b64 v[32:33], 0
    v_mov_b64 v[34:35], 0
    v_mov_b64 v[36:37], 0
    v_mov_b64 v[38:39], 0
    v_mfma_f32_32x32x16_bf16 v[40:55], v[72:75], v[16:19], v[56:71]
    s_nop 11
    v_exp_f32 v40, v40
    v_exp_f32 v41, v41
    v_exp_f32 v42, v42
    v_exp_f32 v43, v43
    v_exp_f32 v44, v44
    v_exp_f32 v45, v45
    v_exp_f32 v46, v46
    v_exp_f32 v47, v47
    v_exp_f32 v48, v48
    v_exp_f32 v49, v49
    v_exp_f32 v50, v50
    v_exp_f32 v51, v51
    v_exp_f32 v52, v52
    v_exp_f32 v53, v53
    v_exp_f32 v54, v54
    v_exp_f32 v55, v55
    v_smfmac_f32_32x32x32_bf16 v[24:39], v[104:107], v[40:47], v6
    s_nop 0
    v_smfmac_f32_32x32x32_bf16 v[24:39], v[108:111], v[48:55], v6
    v_mfma_f32_32x32x16_bf16 v[40:55], v[76:79], v[16:19], v[56:71]
    s_nop 11
    v_exp_f32 v40, v40
    v_exp_f32 v41, v41
    v_exp_f32 v42, v42
    v_exp_f32 v43, v43
    v_exp_f32 v44, v44
    v_exp_f32 v45, v45
    v_exp_f32 v46, v46
    v_exp_f32 v47, v47
    v_exp_f32 v48, v48
    v_exp_f32 v49, v49
    v_exp_f32 v50, v50
    v_exp_f32 v51, v51
    v_exp_f32 v52, v52
    v_exp_f32 v53, v53
    v_exp_f32 v54, v54
    v_exp_f32 v55, v55
    v_smfmac_f32_32x32x32_bf16 v[24:39], v[112:115], v[40:47], v6
    s_nop 0
    v_smfmac_f32_32x32x32_bf16 v[24:39], v[116:119], v[48:55], v6
    v_mfma_f32_32x32x16_bf16 v[40:55], v[80:83], v[16:19], v[56:71]
    s_nop 11
    v_exp_f32 v40, v40
    v_exp_f32 v41, v41
    v_exp_f32 v42, v42
    v_exp_f32 v43, v43
    v_exp_f32 v44, v44
    v_exp_f32 v45, v45
    v_exp_f32 v46, v46
    v_exp_f32 v47, v47
    v_exp_f32 v48, v48
    v_exp_f32 v49, v49
    v_exp_f32 v50, v50
    v_exp_f32 v51, v51
    v_exp_f32 v52, v52
    v_exp_f32 v53, v53
    v_exp_f32 v54, v54
    v_exp_f32 v55, v55
    v_smfmac_f32_32x32x32_bf16 v[24:39], v[120:123], v[40:47], v6
    s_nop 0
    v_smfmac_f32_32x32x32_bf16 v[24:39], v[124:127], v[48:55], v6
    v_mfma_f32_32x32x16_bf16 v[40:55], v[84:87], v[16:19], v[56:71]
    s_nop 11
    v_exp_f32 v40, v40
    v_exp_f32 v41, v41
    v_exp_f32 v42, v42
    v_exp_f32 v43, v43
    v_exp_f32 v44, v44
    v_exp_f32 v45, v45
    v_exp_f32 v46, v46
    v_exp_f32 v47, v47
    v_exp_f32 v48, v48
    v_exp_f32 v49, v49
    v_exp_f32 v50, v50
    v_exp_f32 v51, v51
    v_exp_f32 v52, v52
    v_exp_f32 v53, v53
    v_exp_f32 v54, v54
    v_exp_f32 v55, v55
    v_smfmac_f32_32x32x32_bf16 v[24:39], v[128:131], v[40:47], v6
    s_nop 0
    v_smfmac_f32_32x32x32_bf16 v[24:39], v[132:135], v[48:55], v6
    v_mfma_f32_32x32x16_bf16 v[40:55], v[88:91], v[16:19], v[56:71]
    s_nop 11
    v_exp_f32 v40, v40
    v_exp_f32 v41, v41
    v_exp_f32 v42, v42
    v_exp_f32 v43, v43
    v_exp_f32 v44, v44
    v_exp_f32 v45, v45
    v_exp_f32 v46, v46
    v_exp_f32 v47, v47
    v_exp_f32 v48, v48
    v_exp_f32 v49, v49
    v_exp_f32 v50, v50
    v_exp_f32 v51, v51
    v_exp_f32 v52, v52
    v_exp_f32 v53, v53
    v_exp_f32 v54, v54
    v_exp_f32 v55, v55
    v_smfmac_f32_32x32x32_bf16 v[24:39], v[136:139], v[40:47], v6
    s_nop 0
    v_smfmac_f32_32x32x32_bf16 v[24:39], v[140:143], v[48:55], v6
    v_mfma_f32_32x32x16_bf16 v[40:55], v[92:95], v[16:19], v[56:71]
    s_nop 11
    v_exp_f32 v40, v40
    v_exp_f32 v41, v41
    v_exp_f32 v42, v42
    v_exp_f32 v43, v43
    v_exp_f32 v44, v44
    v_exp_f32 v45, v45
    v_exp_f32 v46, v46
    v_exp_f32 v47, v47
    v_exp_f32 v48, v48
    v_exp_f32 v49, v49
    v_exp_f32 v50, v50
    v_exp_f32 v51, v51
    v_exp_f32 v52, v52
    v_exp_f32 v53, v53
    v_exp_f32 v54, v54
    v_exp_f32 v55, v55
    v_smfmac_f32_32x32x32_bf16 v[24:39], v[144:147], v[40:47], v6
    s_nop 0
    v_smfmac_f32_32x32x32_bf16 v[24:39], v[148:151], v[48:55], v6
    v_mfma_f32_32x32x16_bf16 v[40:55], v[96:99], v[16:19], v[56:71]
    s_nop 11
    v_exp_f32 v40, v40
    v_exp_f32 v41, v41
    v_exp_f32 v42, v42
    v_exp_f32 v43, v43
    v_exp_f32 v44, v44
    v_exp_f32 v45, v45
    v_exp_f32 v46, v46
    v_exp_f32 v47, v47
    v_exp_f32 v48, v48
    v_exp_f32 v49, v49
    v_exp_f32 v50, v50
    v_exp_f32 v51, v51
    v_exp_f32 v52, v52
    v_exp_f32 v53, v53
    v_exp_f32 v54, v54
    v_exp_f32 v55, v55
    v_smfmac_f32_32x32x32_bf16 v[24:39], v[152:155], v[40:47], v6
    s_nop 0
    v_smfmac_f32_32x32x32_bf16 v[24:39], v[156:159], v[48:55], v6
    v_mfma_f32_32x32x16_bf16 v[40:55], v[100:103], v[16:19], v[56:71]
    s_nop 11
    v_exp_f32 v40, v40
    v_exp_f32 v41, v41
    v_exp_f32 v42, v42
    v_exp_f32 v43, v43
    v_exp_f32 v44, v44
    v_exp_f32 v45, v45
    v_exp_f32 v46, v46
    v_exp_f32 v47, v47
    v_exp_f32 v48, v48
    v_exp_f32 v49, v49
    v_exp_f32 v50, v50
    v_exp_f32 v51, v51
    v_exp_f32 v52, v52
    v_exp_f32 v53, v53
    v_exp_f32 v54, v54
    v_exp_f32 v55, v55
    v_smfmac_f32_32x32x32_bf16 v[24:39], v[160:163], v[40:47], v6
    s_nop 0
    v_smfmac_f32_32x32x32_bf16 v[24:39], v[164:167], v[48:55], v6
    s_nop 11
    ds_write_b128 v5, v[24:27]
    ds_write_b128 v5, v[28:31] offset:1024
    ds_write_b32 v1, v32 offset:10240
    s_waitcnt lgkmcnt(0)
    s_barrier
    s_barrier
    s_add_u32 s60, s60, 1024
    s_cmp_lt_u32 s60, 9216
    s_cbranch_scc1 L_a_ex0
    s_lshl_b32 s6, s3, 10
    v_add_u32 v25, s6, v4
    ds_read_b128 v[16:19], v25 offset:20480
    s_waitcnt lgkmcnt(0)
    s_lshr_b32 s6, s3, 2
    s_cmp_le_u32 s6, s56
    s_cbranch_scc1 L_a_rejoin
    s_lshr_b32 s7, s4, 5
    s_and_b32 s7, s7, 7
    s_and_b32 s6, s4, 1
    s_add_u32 s7, s7, s6
    s_and_b32 s7, s7, 7
    s_lshl_b32 s7, s7, 16
    s_lshl_b32 s6, s3, 14
    s_add_u32 s6, s6, s7
    s_add_u32 s7, s6, 983040
    buffer_load_dwordx4 v[40:43], v4, s[36:39], s7 offen offset:0 sc1
    buffer_load_dwordx4 v[44:47], v4, s[36:39], s7 offen offset:1024 sc1
    buffer_load_dwordx4 v[48:51], v4, s[36:39], s7 offen offset:2048 sc1
    buffer_load_dwordx4 v[52:55], v4, s[36:39], s7 offen offset:3072 sc1
    s_add_u32 s7, s6, 987136
    buffer_load_dwordx4 v[56:59], v4, s[36:39], s7 offen offset:0 sc1
    s_branch L_a_rejoin
L_helper:
    s_sub_u32 s56, s3, 8
    s_lshl_b32 s57, s56, 14
    s_setprio 0
    s_mov_b32 s40, s10
    s_mov_b32 s41, s11
    s_mov_b32 s42, 524288
    s_mov_b32 s43, 0x20000
    v_lshrrev_b32 v14, 5, v0
    v_lshlrev_b32 v62, 1, v14
    v_and_b32 v13, 7, v0
    v_xor_b32 v62, v62, v13
    v_lshlrev_b32 v62, 4, v62
    v_lshrrev_b32 v63, 3, v0
    v_lshl_add_u32 v62, v63, 10, v62
    v_xor_b32 v63, 64, v62
    v_add_u32 v63, 7168, v63
    s_lshr_b32 s66, s4, 5
    s_and_b32 s66, s66, 7
    s_and_b32 s67, s4, 1
    s_add_u32 s6, s66, s67
    s_and_b32 s6, s6, 7
    s_lshl_b32 s6, s6, 7
    s_lshl_b32 s62, s56, 17
    s_add_u32 s62, s62, s6
    s_add_u32 s63, s57, 94208
    s_lshl_b32 s61, s4, 11
    v_mov_b32 v15, 0
    v_mov_b64 v[16:17], 0
    v_mov_b64 v[18:19], 0
    ds_write_b128 v15, v[16:19]
    ds_write_b128 v15, v[16:19] offset:64
    ds_write_b128 v15, v[16:19] offset:96
    v_lshlrev_b32 v68, 5, v0
    s_lshl_b32 s64, s56, 11
    s_add_u32 s64, s64, 32768
    s_waitcnt lgkmcnt(0)
    s_load_dword s5, s[34:35], 0
    s_lshl_b32 s6, s4, 2
    s_load_dword s58, s[28:29], s6
    s_and_b32 s61, s61, 0x3800
    s_add_u32 m0, s63, s61
    s_lshl3_add_u32 s60, s61, s62
    s_add_u32 s61, s61, 2048
    buffer_load_dwordx4 v62, s[40:43], s60 offen lds
    buffer_load_dwordx4 v63, s[40:43], s60 offen offset:1024 lds
    s_and_b32 s61, s61, 0x3800
    s_add_u32 m0, s63, s61
    s_lshl3_add_u32 s60, s61, s62
    s_add_u32 s61, s61, 2048
    buffer_load_dwordx4 v62, s[40:43], s60 offen lds
    buffer_load_dwordx4 v63, s[40:43], s60 offen offset:1024 lds
    s_setprio 2
    s_barrier
    s_and_b32 s61, s61, 0x3800
    s_add_u32 m0, s63, s61
    s_lshl3_add_u32 s60, s61, s62
    s_add_u32 s61, s61, 2048
    buffer_load_dwordx4 v62, s[40:43], s60 offen lds
    buffer_load_dwordx4 v63, s[40:43], s60 offen offset:1024 lds
    s_and_b32 s61, s61, 0x3800
    s_add_u32 m0, s63, s61
    s_lshl3_add_u32 s60, s61, s62
    s_add_u32 s61, s61, 2048
    buffer_load_dwordx4 v62, s[40:43], s60 offen lds
    buffer_load_dwordx4 v63, s[40:43], s60 offen offset:1024 lds
    s_and_b32 s61, s61, 0x3800
    s_add_u32 m0, s63, s61
    s_lshl3_add_u32 s60, s61, s62
    s_add_u32 s61, s61, 2048
    buffer_load_dwordx4 v62, s[40:43], s60 offen lds
    buffer_load_dwordx4 v63, s[40:43], s60 offen offset:1024 lds
    s_and_b32 s61, s61, 0x3800
    s_add_u32 m0, s63, s61
    s_lshl3_add_u32 s60, s61, s62
    s_add_u32 s61, s61, 2048
    buffer_load_dwordx4 v62, s[40:43], s60 offen lds
    buffer_load_dwordx4 v63, s[40:43], s60 offen offset:1024 lds
    s_and_b32 s61, s61, 0x3800
    s_add_u32 m0, s63, s61
    s_lshl3_add_u32 s60, s61, s62
    s_add_u32 s61, s61, 2048
    buffer_load_dwordx4 v62, s[40:43], s60 offen lds
    buffer_load_dwordx4 v63, s[40:43], s60 offen offset:1024 lds
    s_and_b32 s61, s61, 0x3800
    s_add_u32 m0, s63, s61
    s_lshl3_add_u32 s60, s61, s62
    s_add_u32 s61, s61, 2048
    buffer_load_dwordx4 v62, s[40:43], s60 offen lds
    buffer_load_dwordx4 v63, s[40:43], s60 offen offset:1024 lds
    s_lshl_b32 s68, s4, 2
    s_add_u32 s68, s68, s56
    s_lshl_b32 s68, s68, 10
    s_add_u32 s68, s68, 6553600
    s_xor_b32 s69, s68, 4096
    v_mov_b64 v[64:65], -1
    v_mov_b64 v[66:67], -1
    s_mov_b32 exec_hi, 0xffff
    buffer_store_dwordx4 v[64:67], v4, s[36:39], s68 offen offset:256 sc1
    s_mov_b64 exec, -1
    v_bfe_u32 v166, v0, 3, 1
    v_lshlrev_b32 v166, 9, v166
    v_lshl_add_u32 v166, v13, 4, v166
    s_lshl_b32 s6, s56, 7
    v_add_u32 v166, s6, v166
    buffer_load_dword v164, v68, s[36:39], s64 offen sc1
    v_and_b32 v6, 0x1f0, v4
    s_cmp_lt_u32 s56, 2
    s_cselect_b32 s87, s12, s14
    s_cselect_b32 s88, s13, s15
    s_xor_b32 s6, s67, 0
    s_add_u32 s6, s6, s66
    s_and_b32 s6, s6, 7
    s_lshl_b32 s6, s6, 16
    s_add_u32 s8, s6, s57
    s_xor_b32 s6, s67, 1
    s_add_u32 s6, s6, s66
    s_and_b32 s6, s6, 7
    s_lshl_b32 s6, s6, 16
    s_add_u32 s9, s6, s57
    s_xor_b32 s6, s67, 2
    s_add_u32 s6, s6, s66
    s_and_b32 s6, s6, 7
    s_lshl_b32 s6, s6, 16
    s_add_u32 s10, s6, s57
    s_xor_b32 s6, s67, 3
    s_add_u32 s6, s6, s66
    s_and_b32 s6, s6, 7
    s_lshl_b32 s6, s6, 16
    s_add_u32 s11, s6, s57
    s_xor_b32 s6, s67, 4
    s_add_u32 s6, s6, s66
    s_and_b32 s6, s6, 7
    s_lshl_b32 s6, s6, 16
    s_add_u32 s12, s6, s57
    s_xor_b32 s6, s67, 5
    s_add_u32 s6, s6, s66
    s_and_b32 s6, s6, 7
    s_lshl_b32 s6, s6, 16
    s_add_u32 s13, s6, s57
    s_xor_b32 s6, s67, 6
    s_add_u32 s6, s6, s66
    s_and_b32 s6, s6, 7
    s_lshl_b32 s6, s6, 16
    s_add_u32 s14, s6, s57
    s_xor_b32 s6, s67, 7
    s_add_u32 s6, s6, s66
    s_and_b32 s6, s6, 7
    s_lshl_b32 s6, s6, 16
    s_add_u32 s15, s6, s57
    s_lshr_b32 s70, s56, 1
    s_and_b32 s71, s56, 1
    s_lshl_b32 s6, s4, 1
    s_add_u32 s72, s6, s70
    s_lshl_b32 s6, s72, 12
    s_add_u32 s52, s26, s6
    s_addc_u32 s53, s27, 0
    s_mov_b32 s54, 0x1000
    s_mov_b32 s55, 0x20000
    s_add_u32 s6, s6, 2097152
    s_add_u32 s44, s34, s6
    s_addc_u32 s45, s35, 0
    s_mov_b32 s46, 0x1000
    s_mov_b32 s47, 0x20000
    s_mul_i32 s73, s56, 8320
    s_add_u32 s73, s73, 106496
    s_lshl_b32 s75, s56, 12
    s_add_u32 s75, s75, 77824
    s_mul_i32 s76, s70, 6144
    s_add_u32 s76, s76, 94208
    v_and_b32 v30, 31, v0
    v_and_b32 v2, 1, v0
    v_mul_u32_u24 v2, 0xaaaa, v2
    v_add_u32 v2, 0x4444, v2
    v_lshrrev_b32 v12, 4, v0
    v_lshlrev_b32 v3, 5, v12
    v_xor_b32 v3, v3, v4
    v_bfe_u32 v1, v0, 3, 1
    v_lshlrev_b32 v1, 9, v1
    v_lshl_add_u32 v1, v12, 5, v1
    v_lshl_add_u32 v1, v13, 1, v1
    s_lshl_b32 s6, s56, 7
    v_add_u32 v1, s6, v1
    s_lshl_b32 s6, s70, 10
    s_lshl_b32 s7, s71, 3
    s_add_u32 s6, s6, s7
    s_add_u32 s6, s6, 28672
    v_add_u32 v5, s6, v4
    v_lshlrev_b32 v7, 3, v30
    v_lshl_add_u32 v7, v14, 2, v7
    s_lshl_b32 s74, s56, 2
    s_lshl_b32 s6, s56, 8
    v_add_u32 v7, s6, v7
    v_and_b32 v31, 15, v0
    v_add_u32 v60, 1, v31
    v_and_b32 v61, 3, v60
    v_sub_u32 v60, v60, v61
    v_mul_u32_u24 v61, 4160, v61
    v_lshl_add_u32 v61, v60, 1, v61
    v_lshl_add_u32 v61, v12, 4, v61
    s_mul_i32 s6, s70, 16640
    s_lshl_b32 s7, s71, 8
    s_add_u32 s6, s6, s7
    s_add_u32 s6, s6, 106496
    v_add_u32 v10, s6, v61
    v_sub_u32 v60, 15, v31
    v_lshlrev_b32 v60, 5, v60
    v_lshl_add_u32 v60, v12, 4, v60
    s_add_u32 s6, s76, s7
    v_add_u32 v11, s6, v60
    v_lshlrev_b32 v167, 2, v0
    s_lshl_b32 s77, s56, 11
    s_add_u32 s83, s77, 24576
    s_add_u32 s77, s77, 16384
    s_lshr_b32 s6, s4, 3
    s_lshl_b32 s6, s6, 10
    s_add_u32 s79, s6, 327680
    v_lshlrev_b32 v60, 4, v14
    v_bfe_u32 v61, v0, 4, 1
    v_bfe_u32 v69, v0, 3, 1
    v_lshl_add_u32 v61, v69, 1, v61
    v_lshl_add_u32 v60, v61, 2, v60
    v_bfe_u32 v69, v0, 2, 1
    v_add_u32 v60, v60, v69
    v_lshlrev_b32 v60, 7, v60
    v_xor_b32 v61, s56, v61
    v_lshl_add_u32 v60, v61, 5, v60
    v_and_b32 v69, 3, v0
    v_lshl_add_u32 v60, v69, 3, v60
    v_add_u32 v60, 94208, v60
    s_waitcnt lgkmcnt(0)
    s_add_u32 s5, s5, 0x9e3779b1
    s_lshl_b32 s6, s58, 16
    s_and_b32 s7, s58, 0xffff0000
    s_cmp_eq_u32 s70, 0
    s_cselect_b32 s58, s6, s7
    ds_read_b128 v[16:19], v3 offset:12288
    ds_read_b128 v[20:23], v3 offset:13312
    ds_read_b128 v[24:27], v3 offset:14336
    ds_read_b128 v[28:31], v3 offset:15360
    ds_read_b128 v[32:35], v3 offset:16384
    ds_read_b128 v[36:39], v3 offset:17408
    ds_read_b128 v[40:43], v3 offset:18432
    ds_read_b128 v[44:47], v3 offset:19456
    s_waitcnt vmcnt(0)
    v_cmp_ne_u32 vcc, s5, v164
    s_cbranch_vccz L_h_fc_ok
    s_mov_b32 s78, 20000
L_h_fc:
    buffer_load_dword v164, v68, s[36:39], s64 offen sc1
    s_waitcnt vmcnt(0)
    v_cmp_ne_u32 vcc, s5, v164
    s_cbranch_vccz L_h_fc_ok
    s_sleep 8
    s_sub_u32 s78, s78, 1
    s_cmp_lg_u32 s78, 0
    s_cbranch_scc1 L_h_fc
L_h_fc_ok:
    s_setprio 3
    s_barrier
    ds_read_b64_tr_b16 v[84:85], v60 offset:0
    ds_read_b64_tr_b16 v[86:87], v60 offset:256
    ds_read_b64_tr_b16 v[88:89], v60 offset:4096
    ds_read_b64_tr_b16 v[90:91], v60 offset:4352
    ds_read_b64_tr_b16 v[92:93], v60 offset:8192
    ds_read_b64_tr_b16 v[94:95], v60 offset:8448
    ds_read_b64_tr_b16 v[96:97], v60 offset:12288
    ds_read_b64_tr_b16 v[98:99], v60 offset:12544
    ds_read_b64_tr_b16 v[100:101], v60 offset:16384
    ds_read_b64_tr_b16 v[102:103], v60 offset:16640
    ds_read_b64_tr_b16 v[104:105], v60 offset:20480
    ds_read_b64_tr_b16 v[106:107], v60 offset:20736
    ds_read_b64_tr_b16 v[108:109], v60 offset:24576
    ds_read_b64_tr_b16 v[110:111], v60 offset:24832
    ds_read_b64_tr_b16 v[112:113], v60 offset:28672
    ds_read_b64_tr_b16 v[114:115], v60 offset:28928
    ds_read_b64_tr_b16 v[116:117], v60 offset:32768
    ds_read_b64_tr_b16 v[118:119], v60 offset:33024
    ds_read_b64_tr_b16 v[120:121], v60 offset:36864
    ds_read_b64_tr_b16 v[122:123], v60 offset:37120
    ds_read_b64_tr_b16 v[124:125], v60 offset:40960
    ds_read_b64_tr_b16 v[126:127], v60 offset:41216
    ds_read_b64_tr_b16 v[128:129], v60 offset:45056
    ds_read_b64_tr_b16 v[130:131], v60 offset:45312
    ds_read_b64_tr_b16 v[132:133], v60 offset:49152
    ds_read_b64_tr_b16 v[134:135], v60 offset:49408
    ds_read_b64_tr_b16 v[136:137], v60 offset:53248
    ds_read_b64_tr_b16 v[138:139], v60 offset:53504
    ds_read_b64_tr_b16 v[140:141], v60 offset:57344
    ds_read_b64_tr_b16 v[142:143], v60 offset:57600
    ds_read_b64_tr_b16 v[144:145], v60 offset:61440
    ds_read_b64_tr_b16 v[146:147], v60 offset:61696
    ds_read_b128 v[48:51], v15
    s_waitcnt lgkmcnt(0)
    v_smfmac_f32_16x16x64_bf16 v[48:51], v[16:19], v[84:91], v2
    v_smfmac_f32_16x16x64_bf16 v[48:51], v[20:23], v[92:99], v2
    v_smfmac_f32_16x16x64_bf16 v[48:51], v[24:27], v[100:107], v2
    v_smfmac_f32_16x16x64_bf16 v[48:51], v[28:31], v[108:115], v2
    v_smfmac_f32_16x16x64_bf16 v[48:51], v[32:35], v[116:123], v2
    v_smfmac_f32_16x16x64_bf16 v[48:51], v[36:39], v[124:131], v2
    v_smfmac_f32_16x16x64_bf16 v[48:51], v[40:43], v[132:139], v2
    v_smfmac_f32_16x16x64_bf16 v[48:51], v[44:47], v[140:147], v2
    s_nop 7
    v_add_f32 v12, v48, v49
    v_add_f32 v13, v50, v51
    v_cvt_pk_bf16_f32 v12, v12, v13
    ds_write_b16 v1, v12 offset:1024
    ds_write_b16_d16_hi v1, v12 offset:1040
    v_mov_b32 v12, 1
    v_mov_b32 v13, s74
    ds_write_b32 v13, v12 offset:64
    ds_read_b128 v[156:159], v15
    ds_read_b128 v[16:19], v3 offset:20480
    ds_read_b128 v[20:23], v3 offset:21504
    ds_read_b128 v[24:27], v3 offset:22528
    ds_read_b128 v[28:31], v3 offset:23552
    ds_read_b128 v[32:35], v3 offset:24576
    ds_read_b128 v[36:39], v3 offset:25600
    ds_read_b128 v[40:43], v3 offset:26624
    ds_read_b128 v[44:47], v3 offset:27648
    s_waitcnt lgkmcnt(7)
    v_smfmac_f32_16x16x64_bf16 v[156:159], v[16:19], v[84:91], v2
    s_waitcnt lgkmcnt(6)
    v_smfmac_f32_16x16x64_bf16 v[156:159], v[20:23], v[92:99], v2
    s_waitcnt lgkmcnt(5)
    v_smfmac_f32_16x16x64_bf16 v[156:159], v[24:27], v[100:107], v2
    s_waitcnt lgkmcnt(4)
    v_smfmac_f32_16x16x64_bf16 v[156:159], v[28:31], v[108:115], v2
    s_waitcnt lgkmcnt(3)
    v_smfmac_f32_16x16x64_bf16 v[156:159], v[32:35], v[116:123], v2
    s_waitcnt lgkmcnt(2)
    v_smfmac_f32_16x16x64_bf16 v[156:159], v[36:39], v[124:131], v2
    s_waitcnt lgkmcnt(1)
    v_smfmac_f32_16x16x64_bf16 v[156:159], v[40:43], v[132:139], v2
    s_waitcnt lgkmcnt(0)
    v_smfmac_f32_16x16x64_bf16 v[156:159], v[44:47], v[140:147], v2
    s_nop 7
    v_add_f32 v12, v156, v157
    v_add_f32 v13, v158, v159
    v_cvt_pk_bf16_f32 v12, v12, v13
    ds_write_b16 v1, v12 offset:11264
    ds_write_b16_d16_hi v1, v12 offset:11280
    s_mov_b64 exec, 0xffff
    ds_read_b128 v[156:159], v166 offset:11264
    s_waitcnt lgkmcnt(0)
    buffer_store_dwordx4 v[156:159], v4, s[36:39], s68 offen offset:0 sc1
    s_mov_b64 exec, -1
    v_mov_b64 v[16:17], 0
    v_mov_b64 v[18:19], 0
    v_mov_b64 v[20:21], 0
    v_mov_b64 v[22:23], 0
    v_mov_b64 v[24:25], 0
    v_mov_b64 v[26:27], 0
    v_mov_b64 v[28:29], 0
    v_mov_b64 v[30:31], 0
    v_mov_b64 v[32:33], 0
    v_mov_b64 v[34:35], 0
    v_mov_b64 v[36:37], 0
    v_mov_b64 v[38:39], 0
    v_mov_b64 v[40:41], 0
    v_mov_b64 v[42:43], 0
    v_mov_b64 v[44:45], 0
    v_mov_b64 v[46:47], 0
    s_waitcnt vmcnt(0)
    s_sleep 16
    s_mov_b64 exec, 0xffff
    buffer_load_dwordx4 v[156:159], v4, s[36:39], s69 offen offset:0 sc1
    s_mov_b64 exec, -1
    s_mov_b64 exec, 0xffff
    s_waitcnt vmcnt(0)
    v_cmp_eq_u32 vcc, -1, v156
    s_cbranch_vccnz L_h_qx00
L_h_qb00:
    ds_write_b128 v166, v[156:159] offset:2048
    s_mov_b64 exec, -1
    v_lshlrev_b32 v165, 5, v0
    buffer_load_dword v164, v165, s[36:39], s77 offen sc1
    buffer_load_dword v165, v165, s[36:39], s83 offen sc1
    s_waitcnt lgkmcnt(0)
    s_barrier
    s_setprio 3
    v_lshrrev_b32 v68, 4, v0
    v_lshlrev_b32 v68, 4, v68
    v_xor_b32 v68, v68, v4
    s_lshl_b32 s6, s56, 11
    s_add_u32 s6, s6, 77824
    v_add_u32 v68, s6, v68
    v_xor_b32 v69, 64, v68
    ds_read_b128 v[60:63], v68
    ds_read_b128 v[64:67], v69 offset:1024
    v_lshrrev_b32 v68, 3, v0
    v_and_b32 v69, 0x70, v4
    v_lshl_add_u32 v70, v68, 12, v69
    s_lshr_b32 s6, s4, 5
    s_lshl_b32 s6, s6, 18
    s_lshl_b32 s7, s56, 16
    s_add_u32 s6, s6, s7
    s_and_b32 s7, s4, 31
    s_lshl_b32 s7, s7, 7
    s_sub_u32 s6, s6, s7
    s_add_u32 s6, s6, 2101120
    s_add_u32 s7, s6, 0x8000
    s_waitcnt lgkmcnt(1)
    buffer_store_dwordx4 v[60:63], v70, s[36:39], s6 offen sc1
    s_waitcnt lgkmcnt(0)
    buffer_store_dwordx4 v[64:67], v70, s[36:39], s7 offen sc1
    s_waitcnt vmcnt(3)
    v_cmp_ne_u32 vcc, s5, v164
    s_waitcnt vmcnt(2)
    v_cmp_ne_u32 s[6:7], s5, v165
    s_nop 0
    s_or_b64 vcc, vcc, s[6:7]
    s_cbranch_vccnz L_h_fw_slow
L_h_fw_back:
    s_add_u32 s59, s10, 1048576
    buffer_load_dwordx4 v[148:151], v4, s[36:39], s59 offen offset:0 sc1
    buffer_load_dwordx4 v[152:155], v4, s[36:39], s59 offen offset:1024 sc1
    buffer_load_dwordx4 v[84:87], v4, s[36:39], s59 offen offset:2048 sc1
    buffer_load_dwordx4 v[88:91], v4, s[36:39], s59 offen offset:3072 sc1
    s_add_u32 s59, s10, 1052672
    buffer_load_dwordx4 v[92:95], v4, s[36:39], s59 offen offset:0 sc1
    buffer_load_dwordx4 v[96:99], v4, s[36:39], s59 offen offset:1024 sc1
    buffer_load_dwordx4 v[100:103], v4, s[36:39], s59 offen offset:2048 sc1
    buffer_load_dwordx4 v[104:107], v4, s[36:39], s59 offen offset:3072 sc1
    s_add_u32 s59, s10, 1056768
    buffer_load_dwordx4 v[108:111], v4, s[36:39], s59 offen offset:0 sc1
    buffer_load_dwordx4 v[112:115], v4, s[36:39], s59 offen offset:1024 sc1
    buffer_load_dwordx4 v[116:119], v4, s[36:39], s59 offen offset:2048 sc1
    buffer_load_dwordx4 v[120:123], v4, s[36:39], s59 offen offset:3072 sc1
    s_add_u32 s59, s10, 1060864
    buffer_load_dwordx4 v[124:127], v4, s[36:39], s59 offen offset:0 sc1
    buffer_load_dwordx4 v[128:131], v4, s[36:39], s59 offen offset:1024 sc1
    buffer_load_dwordx4 v[132:135], v4, s[36:39], s59 offen offset:2048 sc1
    buffer_load_dwordx4 v[136:139], v4, s[36:39], s59 offen offset:3072 sc1
    s_waitcnt vmcnt(16)
    s_lshr_b32 s6, s4, 5
    s_lshl_b32 s6, s6, 2
    s_add_u32 s6, s6, s56
    s_lshl_b32 s6, s6, 5
    s_and_b32 s7, s4, 31
    s_add_u32 s6, s6, s7
    s_lshl_b32 s6, s6, 5
    s_add_u32 s6, s6, 327680
    v_mov_b32 v64, s5
    v_mov_b32 v65, s5
    v_mov_b32 v66, s5
    v_mov_b32 v67, s5
    s_mov_b64 exec, 3
    buffer_store_dwordx4 v[64:67], v4, s[36:39], s6 offen sc1
    s_mov_b64 exec, -1
    s_add_u32 m0, s73, 64
    s_lshl_b32 s6, s71, 2
    buffer_load_dwordx4 v4, s[52:55], s6 offen offset:0 lds
    buffer_load_dwordx4 v4, s[52:55], s6 offen offset:1024 lds
    buffer_load_dwordx4 v4, s[52:55], s6 offen offset:2048 lds
    buffer_load_dwordx4 v4, s[52:55], s6 offen offset:3072 lds
    v_lshrrev_b32 v12, 5, v0
    v_lshrrev_b32 v13, 3, v6
    v_lshl_add_u32 v165, v12, 1, v13
    s_sub_u32 s6, s6, 64
    v_add_u32 v165, s6, v165
    buffer_load_ushort v165, v165, s[52:55], 0 offen
    v_mul_u32_u24 v14, 4160, v12
    v_add3_u32 v14, v14, v13, s73
    s_waitcnt lgkmcnt(0)
    s_barrier
    ds_read_b128 v[76:79], v4 offset:10240
    ds_read_b64 v[60:61], v5 offset:0
    ds_read_b64 v[62:63], v5 offset:2048
    ds_read_b64 v[64:65], v5 offset:4096
    ds_read_b64 v[66:67], v5 offset:6144
    ds_read_b64 v[68:69], v5 offset:8192
    ds_read_b64 v[70:71], v5 offset:10240
    ds_read_b64 v[72:73], v5 offset:12288
    ds_read_b64 v[74:75], v5 offset:14336
    s_waitcnt lgkmcnt(8)
    v_add_f32 v76, v76, v77
    v_add_f32 v78, v78, v79
    v_add_f32 v77, v76, v78
    v_add_f32 v76, v76, v78
    s_nop 1
    v_permlane32_swap_b32 v76, v77
    v_add_f32 v76, v76, v77
    v_rcp_f32 v78, v76
    s_nop 0
    v_max_f32 v9, v76, v78
    s_waitcnt lgkmcnt(0)
    v_add_f32 v60, v60, v62
    v_add_f32 v61, v61, v63
    v_add_f32 v60, v60, v64
    v_add_f32 v61, v61, v65
    v_add_f32 v60, v60, v66
    v_add_f32 v61, v61, v67
    v_add_f32 v60, v60, v68
    v_add_f32 v61, v61, v69
    v_add_f32 v60, v60, v70
    v_add_f32 v61, v61, v71
    v_add_f32 v60, v60, v72
    v_add_f32 v61, v61, v73
    v_add_f32 v60, v60, v74
    v_add_f32 v61, v61, v75
    v_mul_f32 v60, v60, v78
    v_mul_f32 v61, v61, v78
    v_cvt_pk_bf16_f32 v60, v60, v61
    ds_write_b32 v7, v60 offset:9216
    ds_read_b128 v[48:51], v15
    ds_read_b128 v[156:159], v15
    ds_read_b128 v[52:55], v3 offset:12288
    ds_read_b128 v[56:59], v3 offset:20480
    ds_read_b128 v[160:163], v3 offset:13312
    s_waitcnt lgkmcnt(2) vmcnt(20)
    v_smfmac_f32_16x16x64_bf16 v[48:51], v[52:55], v[148:155], v2
    ds_read_b128 v[52:55], v3 offset:21504
    s_waitcnt lgkmcnt(2)
    v_smfmac_f32_16x16x64_bf16 v[156:159], v[56:59], v[148:155], v2
    s_add_u32 s59, s8, 1572864
    buffer_load_dwordx4 v[140:143], v4, s[36:39], s59 offen offset:0 sc1
    buffer_load_dwordx4 v[144:147], v4, s[36:39], s59 offen offset:1024 sc1
    buffer_load_dwordx4 v[148:151], v4, s[36:39], s59 offen offset:2048 sc1
    buffer_load_dwordx4 v[152:155], v4, s[36:39], s59 offen offset:3072 sc1
    ds_read_b128 v[56:59], v3 offset:14336
    s_waitcnt vmcnt(22) lgkmcnt(2)
    v_smfmac_f32_16x16x64_bf16 v[48:51], v[160:163], v[84:91], v2
    ds_read_b128 v[160:163], v3 offset:22528
    s_waitcnt lgkmcnt(2)
    v_smfmac_f32_16x16x64_bf16 v[156:159], v[52:55], v[84:91], v2
    s_add_u32 s59, s8, 1576960
    buffer_load_dwordx4 v[84:87], v4, s[36:39], s59 offen offset:0 sc1
    buffer_load_dwordx4 v[88:91], v4, s[36:39], s59 offen offset:1024 sc1
    ds_read_b128 v[52:55], v3 offset:15360
    s_waitcnt lgkmcnt(2) vmcnt(22)
    v_smfmac_f32_16x16x64_bf16 v[48:51], v[56:59], v[92:99], v2
    ds_read_b128 v[56:59], v3 offset:23552
    s_waitcnt lgkmcnt(2)
    v_smfmac_f32_16x16x64_bf16 v[156:159], v[160:163], v[92:99], v2
    buffer_load_dwordx4 v[92:95], v4, s[36:39], s59 offen offset:2048 sc1
    buffer_load_dwordx4 v[96:99], v4, s[36:39], s59 offen offset:3072 sc1
    ds_read_b128 v[160:163], v3 offset:16384
    s_waitcnt vmcnt(22) lgkmcnt(2)
    v_smfmac_f32_16x16x64_bf16 v[48:51], v[52:55], v[100:107], v2
    ds_read_b128 v[52:55], v3 offset:24576
    s_waitcnt lgkmcnt(2)
    v_smfmac_f32_16x16x64_bf16 v[156:159], v[56:59], v[100:107], v2
    s_add_u32 s59, s8, 1581056
    buffer_load_dwordx4 v[100:103], v4, s[36:39], s59 offen offset:0 sc1
    buffer_load_dwordx4 v[104:107], v4, s[36:39], s59 offen offset:1024 sc1
    ds_read_b128 v[56:59], v3 offset:17408
    s_waitcnt vmcnt(22) lgkmcnt(2)
    v_smfmac_f32_16x16x64_bf16 v[48:51], v[160:163], v[108:115], v2
    ds_read_b128 v[160:163], v3 offset:25600
    s_waitcnt lgkmcnt(2)
    v_smfmac_f32_16x16x64_bf16 v[156:159], v[52:55], v[108:115], v2
    buffer_load_dwordx4 v[108:111], v4, s[36:39], s59 offen offset:2048 sc1
    buffer_load_dwordx4 v[112:115], v4, s[36:39], s59 offen offset:3072 sc1
    ds_read_b128 v[52:55], v3 offset:18432
    s_waitcnt lgkmcnt(2) vmcnt(22)
    v_smfmac_f32_16x16x64_bf16 v[48:51], v[56:59], v[116:123], v2
    ds_read_b128 v[56:59], v3 offset:26624
    s_waitcnt lgkmcnt(2)
    v_smfmac_f32_16x16x64_bf16 v[156:159], v[160:163], v[116:123], v2
    s_add_u32 s59, s8, 1585152
    buffer_load_dwordx4 v[116:119], v4, s[36:39], s59 offen offset:0 sc1
    buffer_load_dwordx4 v[120:123], v4, s[36:39], s59 offen offset:1024 sc1
    ds_read_b128 v[160:163], v3 offset:19456
    s_waitcnt vmcnt(22) lgkmcnt(2)
    v_smfmac_f32_16x16x64_bf16 v[48:51], v[52:55], v[124:131], v2
    ds_read_b128 v[52:55], v3 offset:27648
    s_waitcnt lgkmcnt(2)
    v_smfmac_f32_16x16x64_bf16 v[156:159], v[56:59], v[124:131], v2
    buffer_load_dwordx4 v[124:127], v4, s[36:39], s59 offen offset:2048 sc1
    buffer_load_dwordx4 v[128:131], v4, s[36:39], s59 offen offset:3072 sc1
    s_waitcnt vmcnt(22) lgkmcnt(1)
    v_smfmac_f32_16x16x64_bf16 v[48:51], v[160:163], v[132:139], v2
    s_waitcnt lgkmcnt(0)
    v_smfmac_f32_16x16x64_bf16 v[156:159], v[52:55], v[132:139], v2
    s_nop 3
    v_add_f32 v12, v48, v49
    v_add_f32 v13, v50, v51
    v_cvt_pk_bf16_f32 v12, v12, v13
    ds_write_b16 v1, v12 offset:3072
    ds_write_b16_d16_hi v1, v12 offset:3088
    v_add_f32 v12, v156, v157
    v_add_f32 v13, v158, v159
    v_cvt_pk_bf16_f32 v12, v12, v13
    ds_write_b16 v1, v12 offset:11264
    ds_write_b16_d16_hi v1, v12 offset:11280
    s_mov_b64 exec, 0xffff
    ds_read_b128 v[156:159], v166 offset:11264
    s_waitcnt lgkmcnt(0)
    buffer_store_dwordx4 v[156:159], v4, s[36:39], s68 offen offset:256 sc1
    s_mov_b64 exec, -1
    s_waitcnt lgkmcnt(0)
    s_barrier
    ds_read2st64_b32 v[52:53], v167 offset0:36 offset1:37
    ds_read2st64_b32 v[54:55], v167 offset0:38 offset1:39
    s_waitcnt vmcnt(17)
    ds_write_b16 v14, v165
    v_add_u32 v165, s73, v4
    ds_read_b128 v[60:63], v165 offset:64
    ds_read_b32 v64, v165 offset:80
    ds_read_b128 v[66:69], v165 offset:1088
    ds_read_b32 v70, v165 offset:1104
    ds_read_b128 v[72:75], v165 offset:2112
    ds_read_b32 v76, v165 offset:2128
    ds_read_b128 v[78:81], v165 offset:3136
    ds_read_b32 v82, v165 offset:3152
    s_waitcnt vmcnt(15) lgkmcnt(9)
    v_smfmac_f32_16x16x64_bf16 v[16:19], v[52:55], v[140:147], v2
    s_add_u32 s59, s9, 1572864
    buffer_load_dwordx4 v[132:135], v4, s[36:39], s59 offen offset:0 sc1
    buffer_load_dwordx4 v[136:139], v4, s[36:39], s59 offen offset:1024 sc1
    buffer_load_dwordx4 v[140:143], v4, s[36:39], s59 offen offset:2048 sc1
    buffer_load_dwordx4 v[144:147], v4, s[36:39], s59 offen offset:3072 sc1
    s_waitcnt lgkmcnt(7)
    v_alignbit_b32 v60, v61, v60, 16
    v_alignbit_b32 v61, v62, v61, 16
    v_alignbit_b32 v62, v63, v62, 16
    s_waitcnt lgkmcnt(6)
    v_alignbit_b32 v63, v64, v63, 16
    ds_write_b128 v165, v[60:63] offset:4224
    s_waitcnt vmcnt(17)
    v_smfmac_f32_16x16x64_bf16 v[20:23], v[52:55], v[148:155], v2
    s_add_u32 s59, s9, 1576960
    buffer_load_dwordx4 v[148:151], v4, s[36:39], s59 offen offset:0 sc1
    buffer_load_dwordx4 v[152:155], v4, s[36:39], s59 offen offset:1024 sc1
    s_waitcnt vmcnt(17)
    v_smfmac_f32_16x16x64_bf16 v[24:27], v[52:55], v[84:91], v2
    s_waitcnt lgkmcnt(6)
    v_alignbit_b32 v66, v67, v66, 16
    v_alignbit_b32 v67, v68, v67, 16
    v_alignbit_b32 v68, v69, v68, 16
    s_waitcnt lgkmcnt(5)
    v_alignbit_b32 v69, v70, v69, 16
    ds_write_b128 v165, v[66:69] offset:5248
    s_waitcnt vmcnt(15)
    v_smfmac_f32_16x16x64_bf16 v[28:31], v[52:55], v[92:99], v2
    s_waitcnt vmcnt(13)
    v_smfmac_f32_16x16x64_bf16 v[32:35], v[52:55], v[100:107], v2
    s_waitcnt lgkmcnt(5)
    v_alignbit_b32 v72, v73, v72, 16
    v_alignbit_b32 v73, v74, v73, 16
    v_alignbit_b32 v74, v75, v74, 16
    s_waitcnt lgkmcnt(4)
    v_alignbit_b32 v75, v76, v75, 16
    ds_write_b128 v165, v[72:75] offset:6272
    s_waitcnt vmcnt(11)
    v_smfmac_f32_16x16x64_bf16 v[36:39], v[52:55], v[108:115], v2
    s_waitcnt vmcnt(9)
    v_smfmac_f32_16x16x64_bf16 v[40:43], v[52:55], v[116:123], v2
    buffer_load_dwordx4 v[116:119], v4, s[36:39], s59 offen offset:2048 sc1
    buffer_load_dwordx4 v[120:123], v4, s[36:39], s59 offen offset:3072 sc1
    s_waitcnt lgkmcnt(4)
    v_alignbit_b32 v78, v79, v78, 16
    v_alignbit_b32 v79, v80, v79, 16
    v_alignbit_b32 v80, v81, v80, 16
    s_waitcnt lgkmcnt(3)
    v_alignbit_b32 v81, v82, v81, 16
    ds_write_b128 v165, v[78:81] offset:7296
    s_waitcnt vmcnt(9)
    v_smfmac_f32_16x16x64_bf16 v[44:47], v[52:55], v[124:131], v2
    s_add_u32 s59, s9, 1581056
    buffer_load_dwordx4 v[124:127], v4, s[36:39], s59 offen offset:0 sc1
    buffer_load_dwordx4 v[128:131], v4, s[36:39], s59 offen offset:1024 sc1
    v_lshlrev_b32 v164, 1, v6
    buffer_load_dword v164, v164, s[36:39], s79 offen sc1
    s_waitcnt lgkmcnt(0)
    s_barrier
    s_waitcnt vmcnt(0)
    v_cmp_ne_u32 vcc, s5, v164
    s_cbranch_vccnz L_h_fu_slow
L_h_fu_back:
    s_mul_i32 s6, s71, 3072
    v_add_u32 v164, s6, v4
    s_add_u32 m0, s6, s76
    s_nop 0
    buffer_load_dwordx4 v164, s[44:47], 0 offen offset:0 sc1 lds
    buffer_load_dwordx4 v164, s[44:47], 0 offen offset:1024 sc1 lds
    buffer_load_dwordx4 v164, s[44:47], 0 offen offset:2048 sc1 lds
    s_mov_b64 exec, 0xffff
    buffer_load_dwordx4 v[156:159], v4, s[36:39], s69 offen offset:256 sc1
    s_mov_b64 exec, -1
    ds_read_b128 v[76:79], v4 offset:10240
    ds_read_b64 v[60:61], v5 offset:0
    ds_read_b64 v[62:63], v5 offset:2048
    ds_read_b64 v[64:65], v5 offset:4096
    ds_read_b64 v[66:67], v5 offset:6144
    ds_read_b64 v[68:69], v5 offset:8192
    ds_read_b64 v[70:71], v5 offset:10240
    ds_read_b64 v[72:73], v5 offset:12288
    ds_read_b64 v[74:75], v5 offset:14336
    s_waitcnt lgkmcnt(8)
    v_add_f32 v76, v76, v77
    v_add_f32 v78, v78, v79
    v_add_f32 v77, v76, v78
    v_add_f32 v76, v76, v78
    s_nop 1
    v_permlane32_swap_b32 v76, v77
    v_add_f32 v76, v76, v77
    v_rcp_f32 v78, v76
    s_nop 0
    v_max3_f32 v9, v9, v76, v78
    s_waitcnt lgkmcnt(0)
    v_add_f32 v60, v60, v62
    v_add_f32 v61, v61, v63
    v_add_f32 v60, v60, v64
    v_add_f32 v61, v61, v65
    v_add_f32 v60, v60, v66
    v_add_f32 v61, v61, v67
    v_add_f32 v60, v60, v68
    v_add_f32 v61, v61, v69
    v_add_f32 v60, v60, v70
    v_add_f32 v61, v61, v71
    v_add_f32 v60, v60, v72
    v_add_f32 v61, v61, v73
    v_add_f32 v60, v60, v74
    v_add_f32 v61, v61, v75
    v_mul_f32 v60, v60, v78
    v_mul_f32 v61, v61, v78
    v_cvt_pk_bf16_f32 v60, v60, v61
    ds_write_b32 v7, v60 offset:9216
    v_lshrrev_b32 v68, 3, v0
    v_and_b32 v69, 0x70, v4
    v_lshl_add_u32 v70, v68, 10, v69
    s_lshl_b32 s6, s4, 13
    s_lshl_b32 s7, s56, 8
    s_add_u32 s6, s6, s7
    s_add_u32 s80, s6, 8650752
    v_mov_b64 v[64:65], -1
    v_mov_b64 v[66:67], -1
    s_add_u32 s6, s68, 1048576
    buffer_store_dwordx4 v[64:67], v70, s[36:39], s80 offen sc1
    buffer_store_dwordx4 v[64:67], v70, s[36:39], s80 offen offset:128 sc1
    buffer_store_dwordx4 v[64:67], v4, s[36:39], s6 offen sc1
    s_mov_b64 exec, 0xffff
    s_waitcnt vmcnt(3)
    v_cmp_eq_u32 vcc, -1, v156
    s_cbranch_vccnz L_h_qx01
L_h_qb01:
    ds_write_b128 v166, v[156:159] offset:4096
    s_mov_b64 exec, -1
    s_waitcnt lgkmcnt(0)
    s_barrier
    ds_read2st64_b32 v[52:53], v167 offset0:36 offset1:37
    ds_read2st64_b32 v[54:55], v167 offset0:38 offset1:39
    ds_read_b64 v[76:77], v10 offset:32
    ds_read_b64 v[78:79], v10 offset:40
    ds_read_b128 v[72:75], v11 offset:2048
    ds_read_b128 v[68:71], v11 offset:2560
    ds_read_b128 v[64:67], v11 offset:3072
    ds_read_b128 v[60:63], v11 offset:3584
    ds_read_b64 v[80:81], v10 offset:544
    ds_read_b64 v[82:83], v10 offset:552
    s_waitcnt lgkmcnt(5)
    v_mfma_f32_16x16x32_bf16 v[96:99], v[76:79], v[72:75], 0
    s_waitcnt lgkmcnt(4)
    v_mfma_f32_16x16x32_bf16 v[92:95], v[76:79], v[68:71], 0
    v_smfmac_f32_16x16x64_bf16 v[16:19], v[52:55], v[132:139], v2
    buffer_load_dwordx4 v[132:135], v4, s[36:39], s59 offen offset:2048 sc1
    buffer_load_dwordx4 v[136:139], v4, s[36:39], s59 offen offset:3072 sc1
    s_waitcnt lgkmcnt(3)
    v_mfma_f32_16x16x32_bf16 v[88:91], v[76:79], v[64:67], 0
    s_waitcnt lgkmcnt(2)
    v_mfma_f32_16x16x32_bf16 v[84:87], v[76:79], v[60:63], 0
    ds_read_b64 v[76:77], v10 offset:1056
    ds_read_b64 v[78:79], v10 offset:1064
    v_smfmac_f32_16x16x64_bf16 v[20:23], v[52:55], v[140:147], v2
    s_add_u32 s59, s9, 1585152
    buffer_load_dwordx4 v[140:143], v4, s[36:39], s59 offen offset:0 sc1
    buffer_load_dwordx4 v[144:147], v4, s[36:39], s59 offen offset:1024 sc1
    s_waitcnt lgkmcnt(2)
    v_mfma_f32_16x16x32_bf16 v[100:103], v[80:83], v[72:75], 0
    v_mfma_f32_16x16x32_bf16 v[96:99], v[80:83], v[68:71], v[96:99]
    v_smfmac_f32_16x16x64_bf16 v[24:27], v[52:55], v[148:155], v2
    buffer_load_dwordx4 v[148:151], v4, s[36:39], s59 offen offset:2048 sc1
    buffer_load_dwordx4 v[152:155], v4, s[36:39], s59 offen offset:3072 sc1
    v_mfma_f32_16x16x32_bf16 v[92:95], v[80:83], v[64:67], v[92:95]
    v_mfma_f32_16x16x32_bf16 v[88:91], v[80:83], v[60:63], v[88:91]
    ds_read_b64 v[80:81], v10 offset:1568
    ds_read_b64 v[82:83], v10 offset:1576
    v_smfmac_f32_16x16x64_bf16 v[28:31], v[52:55], v[116:123], v2
    s_add_u32 s59, s12, 1048576
    buffer_load_dwordx4 v[116:119], v4, s[36:39], s59 offen offset:0 sc1
    buffer_load_dwordx4 v[120:123], v4, s[36:39], s59 offen offset:1024 sc1
    s_waitcnt lgkmcnt(2)
    v_mfma_f32_16x16x32_bf16 v[104:107], v[76:79], v[72:75], 0
    v_mfma_f32_16x16x32_bf16 v[100:103], v[76:79], v[68:71], v[100:103]
    v_mfma_f32_16x16x32_bf16 v[96:99], v[76:79], v[64:67], v[96:99]
    v_smfmac_f32_16x16x64_bf16 v[32:35], v[52:55], v[124:131], v2
    buffer_load_dwordx4 v[124:127], v4, s[36:39], s59 offen offset:2048 sc1
    buffer_load_dwordx4 v[128:131], v4, s[36:39], s59 offen offset:3072 sc1
    v_mfma_f32_16x16x32_bf16 v[92:95], v[76:79], v[60:63], v[92:95]
    ds_read_b64 v[76:77], v10 offset:2080
    ds_read_b64 v[78:79], v10 offset:2088
    s_waitcnt lgkmcnt(2)
    v_mfma_f32_16x16x32_bf16 v[108:111], v[80:83], v[72:75], 0
    s_waitcnt vmcnt(8)
    v_smfmac_f32_16x16x64_bf16 v[36:39], v[52:55], v[132:139], v2
    s_add_u32 s59, s12, 1052672
    buffer_load_dwordx4 v[132:135], v4, s[36:39], s59 offen offset:0 sc1
    buffer_load_dwordx4 v[136:139], v4, s[36:39], s59 offen offset:1024 sc1
    v_mfma_f32_16x16x32_bf16 v[104:107], v[80:83], v[68:71], v[104:107]
    v_mfma_f32_16x16x32_bf16 v[100:103], v[80:83], v[64:67], v[100:103]
    s_waitcnt vmcnt(8)
    v_smfmac_f32_16x16x64_bf16 v[40:43], v[52:55], v[140:147], v2
    buffer_load_dwordx4 v[140:143], v4, s[36:39], s59 offen offset:2048 sc1
    buffer_load_dwordx4 v[144:147], v4, s[36:39], s59 offen offset:3072 sc1
    v_mfma_f32_16x16x32_bf16 v[96:99], v[80:83], v[60:63], v[96:99]
    ds_read_b64 v[80:81], v10 offset:2592
    ds_read_b64 v[82:83], v10 offset:2600
    s_waitcnt lgkmcnt(2)
    v_mfma_f32_16x16x32_bf16 v[112:115], v[76:79], v[72:75], 0
    s_waitcnt vmcnt(8)
    v_smfmac_f32_16x16x64_bf16 v[44:47], v[52:55], v[148:155], v2
    s_add_u32 s59, s12, 1056768
    buffer_load_dwordx4 v[148:151], v4, s[36:39], s59 offen offset:0 sc1
    buffer_load_dwordx4 v[152:155], v4, s[36:39], s59 offen offset:1024 sc1
    v_mfma_f32_16x16x32_bf16 v[108:111], v[76:79], v[68:71], v[108:111]
    v_mfma_f32_16x16x32_bf16 v[104:107], v[76:79], v[64:67], v[104:107]
    v_mfma_f32_16x16x32_bf16 v[100:103], v[76:79], v[60:63], v[100:103]
    ds_read_b64 v[76:77], v10 offset:3104
    ds_read_b64 v[78:79], v10 offset:3112
    ds_read_b128 v[48:51], v15
    ds_read_b128 v[156:159], v15
    ds_read_b128 v[52:55], v3 offset:12288
    ds_read_b128 v[56:59], v3 offset:20480
    s_waitcnt lgkmcnt(6)
    v_mfma_f32_16x16x32_bf16 v[112:115], v[80:83], v[68:71], v[112:115]
    v_mfma_f32_16x16x32_bf16 v[108:111], v[80:83], v[64:67], v[108:111]
    ds_read_b128 v[160:163], v3 offset:13312
    s_waitcnt lgkmcnt(2) vmcnt(8)
    v_smfmac_f32_16x16x64_bf16 v[48:51], v[52:55], v[116:123], v2
    ds_read_b128 v[52:55], v3 offset:21504
    s_waitcnt lgkmcnt(2)
    v_smfmac_f32_16x16x64_bf16 v[156:159], v[56:59], v[116:123], v2
    buffer_load_dwordx4 v[116:119], v4, s[36:39], s59 offen offset:2048 sc1
    buffer_load_dwordx4 v[120:123], v4, s[36:39], s59 offen offset:3072 sc1
    v_mfma_f32_16x16x32_bf16 v[104:107], v[80:83], v[60:63], v[104:107]
    ds_read_b64 v[80:81], v10 offset:3616
    ds_read_b64 v[82:83], v10 offset:3624
    v_mfma_f32_16x16x32_bf16 v[112:115], v[76:79], v[64:67], v[112:115]
    ds_read_b128 v[56:59], v3 offset:14336
    s_waitcnt vmcnt(8) lgkmcnt(4)
    v_smfmac_f32_16x16x64_bf16 v[48:51], v[160:163], v[124:131], v2
    ds_read_b128 v[160:163], v3 offset:22528
    s_waitcnt lgkmcnt(4)
    v_smfmac_f32_16x16x64_bf16 v[156:159], v[52:55], v[124:131], v2
    s_add_u32 s59, s12, 1060864
    buffer_load_dwordx4 v[124:127], v4, s[36:39], s59 offen offset:0 sc1
    buffer_load_dwordx4 v[128:131], v4, s[36:39], s59 offen offset:1024 sc1
    v_mfma_f32_16x16x32_bf16 v[108:111], v[76:79], v[60:63], v[108:111]
    s_waitcnt lgkmcnt(2)
    v_mfma_f32_16x16x32_bf16 v[112:115], v[80:83], v[60:63], v[112:115]
    s_waitcnt lgkmcnt(0)
    s_barrier
    ds_read_b128 v[76:79], v4 offset:10240
    ds_read_b64 v[60:61], v5 offset:0
    ds_read_b64 v[62:63], v5 offset:2048
    ds_read_b64 v[64:65], v5 offset:4096
    ds_read_b64 v[66:67], v5 offset:6144
    ds_read_b64 v[68:69], v5 offset:8192
    ds_read_b64 v[70:71], v5 offset:10240
    ds_read_b64 v[72:73], v5 offset:12288
    ds_read_b64 v[74:75], v5 offset:14336
    s_waitcnt lgkmcnt(8)
    v_add_f32 v76, v76, v77
    v_add_f32 v78, v78, v79
    v_add_f32 v77, v76, v78
    v_add_f32 v76, v76, v78
    s_nop 1
    v_permlane32_swap_b32 v76, v77
    v_add_f32 v76, v76, v77
    v_rcp_f32 v78, v76
    s_nop 0
    v_max3_f32 v9, v9, v76, v78
    s_waitcnt lgkmcnt(0)
    v_add_f32 v60, v60, v62
    v_add_f32 v61, v61, v63
    v_add_f32 v60, v60, v64
    v_add_f32 v61, v61, v65
    v_add_f32 v60, v60, v66
    v_add_f32 v61, v61, v67
    v_add_f32 v60, v60, v68
    v_add_f32 v61, v61, v69
    v_add_f32 v60, v60, v70
    v_add_f32 v61, v61, v71
    v_add_f32 v60, v60, v72
    v_add_f32 v61, v61, v73
    v_add_f32 v60, v60, v74
    v_add_f32 v61, v61, v75
    v_mul_f32 v60, v60, v78
    v_mul_f32 v61, v61, v78
    v_cvt_pk_bf16_f32 v60, v60, v61
    ds_write_b32 v7, v60 offset:9216
    ds_read_b128 v[52:55], v3 offset:15360
    s_waitcnt vmcnt(8)
    v_smfmac_f32_16x16x64_bf16 v[48:51], v[56:59], v[132:139], v2
    ds_read_b128 v[56:59], v3 offset:23552
    v_smfmac_f32_16x16x64_bf16 v[156:159], v[160:163], v[132:139], v2
    buffer_load_dwordx4 v[132:135], v4, s[36:39], s59 offen offset:2048 sc1
    buffer_load_dwordx4 v[136:139], v4, s[36:39], s59 offen offset:3072 sc1
    ds_read_b64 v[76:77], v10 offset:32
    ds_read_b64 v[78:79], v10 offset:40
    ds_read_b128 v[72:75], v11 offset:0
    ds_read_b128 v[68:71], v11 offset:512
    ds_read_b128 v[64:67], v11 offset:1024
    ds_read_b128 v[60:63], v11 offset:1536
    ds_read_b64 v[80:81], v10 offset:544
    ds_read_b64 v[82:83], v10 offset:552
    s_waitcnt lgkmcnt(5)
    v_mfma_f32_16x16x32_bf16 v[112:115], v[76:79], v[72:75], v[112:115]
    ds_read_b128 v[72:75], v11 offset:2112
    s_waitcnt lgkmcnt(5)
    v_mfma_f32_16x16x32_bf16 v[108:111], v[76:79], v[68:71], v[108:111]
    ds_read_b128 v[160:163], v3 offset:16384
    s_waitcnt vmcnt(8)
    v_smfmac_f32_16x16x64_bf16 v[48:51], v[52:55], v[140:147], v2
    ds_read_b128 v[52:55], v3 offset:24576
    v_smfmac_f32_16x16x64_bf16 v[156:159], v[56:59], v[140:147], v2
    s_add_u32 s59, s10, 1572864
    buffer_load_dwordx4 v[140:143], v4, s[36:39], s59 offen offset:0 sc1
    buffer_load_dwordx4 v[144:147], v4, s[36:39], s59 offen offset:1024 sc1
    s_waitcnt lgkmcnt(6)
    v_mfma_f32_16x16x32_bf16 v[104:107], v[76:79], v[64:67], v[104:107]
    s_waitcnt lgkmcnt(5)
    v_mfma_f32_16x16x32_bf16 v[100:103], v[76:79], v[60:63], v[100:103]
    ds_read_b64 v[76:77], v10 offset:1056
    ds_read_b64 v[78:79], v10 offset:1064
    ds_read_b128 v[56:59], v3 offset:17408
    s_waitcnt vmcnt(8) lgkmcnt(4)
    v_smfmac_f32_16x16x64_bf16 v[48:51], v[160:163], v[148:155], v2
    ds_read_b128 v[160:163], v3 offset:25600
    s_waitcnt lgkmcnt(4)
    v_smfmac_f32_16x16x64_bf16 v[156:159], v[52:55], v[148:155], v2
    buffer_load_dwordx4 v[148:151], v4, s[36:39], s59 offen offset:2048 sc1
    buffer_load_dwordx4 v[152:155], v4, s[36:39], s59 offen offset:3072 sc1
    v_mfma_f32_16x16x32_bf16 v[112:115], v[80:83], v[68:71], v[112:115]
    ds_read_b128 v[68:71], v11 offset:2624
    v_mfma_f32_16x16x32_bf16 v[108:111], v[80:83], v[64:67], v[108:111]
    v_mfma_f32_16x16x32_bf16 v[104:107], v[80:83], v[60:63], v[104:107]
    ds_read_b64 v[80:81], v10 offset:1568
    ds_read_b64 v[82:83], v10 offset:1576
    ds_read_b128 v[52:55], v3 offset:18432
    s_waitcnt lgkmcnt(5) vmcnt(8)
    v_smfmac_f32_16x16x64_bf16 v[48:51], v[56:59], v[116:123], v2
    ds_read_b128 v[56:59], v3 offset:26624
    s_waitcnt lgkmcnt(5)
    v_smfmac_f32_16x16x64_bf16 v[156:159], v[160:163], v[116:123], v2
    s_add_u32 s59, s10, 1576960
    buffer_load_dwordx4 v[116:119], v4, s[36:39], s59 offen offset:0 sc1
    buffer_load_dwordx4 v[120:123], v4, s[36:39], s59 offen offset:1024 sc1
    v_mfma_f32_16x16x32_bf16 v[112:115], v[76:79], v[64:67], v[112:115]
    ds_read_b128 v[64:67], v11 offset:3136
    v_mfma_f32_16x16x32_bf16 v[108:111], v[76:79], v[60:63], v[108:111]
    ds_read_b64 v[76:77], v10 offset:96
    ds_read_b64 v[78:79], v10 offset:104
    ds_read_b128 v[160:163], v3 offset:19456
    s_waitcnt vmcnt(8) lgkmcnt(5)
    v_smfmac_f32_16x16x64_bf16 v[48:51], v[52:55], v[124:131], v2
    ds_read_b128 v[52:55], v3 offset:27648
    s_waitcnt lgkmcnt(5)
    v_smfmac_f32_16x16x64_bf16 v[156:159], v[56:59], v[124:131], v2
    buffer_load_dwordx4 v[124:127], v4, s[36:39], s59 offen offset:2048 sc1
    buffer_load_dwordx4 v[128:131], v4, s[36:39], s59 offen offset:3072 sc1
    v_mfma_f32_16x16x32_bf16 v[112:115], v[80:83], v[60:63], v[112:115]
    ds_read_b128 v[60:63], v11 offset:3648
    ds_read_b64 v[80:81], v10 offset:608
    ds_read_b64 v[82:83], v10 offset:616
    s_waitcnt lgkmcnt(5)
    v_mfma_f32_16x16x32_bf16 v[96:99], v[76:79], v[72:75], v[96:99]
    s_waitcnt vmcnt(8) lgkmcnt(4)
    v_smfmac_f32_16x16x64_bf16 v[48:51], v[160:163], v[132:139], v2
    s_waitcnt lgkmcnt(3)
    v_smfmac_f32_16x16x64_bf16 v[156:159], v[52:55], v[132:139], v2
    s_add_u32 s59, s10, 1581056
    buffer_load_dwordx4 v[132:135], v4, s[36:39], s59 offen offset:0 sc1
    buffer_load_dwordx4 v[136:139], v4, s[36:39], s59 offen offset:1024 sc1
    v_mfma_f32_16x16x32_bf16 v[92:95], v[76:79], v[68:71], v[92:95]
    v_mfma_f32_16x16x32_bf16 v[88:91], v[76:79], v[64:67], v[88:91]
    s_waitcnt lgkmcnt(2)
    v_mfma_f32_16x16x32_bf16 v[84:87], v[76:79], v[60:63], v[84:87]
    ds_read_b64 v[76:77], v10 offset:1120
    ds_read_b64 v[78:79], v10 offset:1128
    v_add_f32 v12, v48, v49
    v_add_f32 v13, v50, v51
    v_cvt_pk_bf16_f32 v12, v12, v13
    ds_write_b16 v1, v12 offset:5120
    ds_write_b16_d16_hi v1, v12 offset:5136
    s_waitcnt lgkmcnt(4)
    v_mfma_f32_16x16x32_bf16 v[100:103], v[80:83], v[72:75], v[100:103]
    v_mfma_f32_16x16x32_bf16 v[96:99], v[80:83], v[68:71], v[96:99]
    v_add_f32 v12, v156, v157
    v_add_f32 v13, v158, v159
    v_cvt_pk_bf16_f32 v12, v12, v13
    ds_write_b16 v1, v12 offset:11264
    ds_write_b16_d16_hi v1, v12 offset:11280
    s_mov_b64 exec, 0xffff
    ds_read_b128 v[156:159], v166 offset:11264
    s_waitcnt lgkmcnt(0)
    buffer_store_dwordx4 v[156:159], v4, s[36:39], s68 offen offset:512 sc1
    s_mov_b64 exec, -1
    v_mfma_f32_16x16x32_bf16 v[92:95], v[80:83], v[64:67], v[92:95]
    v_mfma_f32_16x16x32_bf16 v[88:91], v[80:83], v[60:63], v[88:91]
    ds_read_b64 v[80:81], v10 offset:1632
    ds_read_b64 v[82:83], v10 offset:1640
    s_waitcnt lgkmcnt(0)
    s_barrier
    ds_read2st64_b32 v[52:53], v167 offset0:36 offset1:37
    ds_read2st64_b32 v[54:55], v167 offset0:38 offset1:39
    v_mfma_f32_16x16x32_bf16 v[104:107], v[76:79], v[72:75], v[104:107]
    v_mfma_f32_16x16x32_bf16 v[100:103], v[76:79], v[68:71], v[100:103]
    v_mfma_f32_16x16x32_bf16 v[96:99], v[76:79], v[64:67], v[96:99]
    v_mfma_f32_16x16x32_bf16 v[92:95], v[76:79], v[60:63], v[92:95]
    ds_read_b64 v[76:77], v10 offset:2144
    ds_read_b64 v[78:79], v10 offset:2152
    s_waitcnt vmcnt(9) lgkmcnt(2)
    v_smfmac_f32_16x16x64_bf16 v[16:19], v[52:55], v[140:147], v2
    buffer_load_dwordx4 v[140:143], v4, s[36:39], s59 offen offset:2048 sc1
    buffer_load_dwordx4 v[144:147], v4, s[36:39], s59 offen offset:3072 sc1
    v_mfma_f32_16x16x32_bf16 v[108:111], v[80:83], v[72:75], v[108:111]
    v_mfma_f32_16x16x32_bf16 v[104:107], v[80:83], v[68:71], v[104:107]
    v_mfma_f32_16x16x32_bf16 v[100:103], v[80:83], v[64:67], v[100:103]
    v_mfma_f32_16x16x32_bf16 v[96:99], v[80:83], v[60:63], v[96:99]
    ds_read_b64 v[80:81], v10 offset:2656
    ds_read_b64 v[82:83], v10 offset:2664
    s_waitcnt vmcnt(9)
    v_smfmac_f32_16x16x64_bf16 v[20:23], v[52:55], v[148:155], v2
    s_add_u32 s59, s10, 1585152
    buffer_load_dwordx4 v[148:151], v4, s[36:39], s59 offen offset:0 sc1
    buffer_load_dwordx4 v[152:155], v4, s[36:39], s59 offen offset:1024 sc1
    s_waitcnt lgkmcnt(2)
    v_mfma_f32_16x16x32_bf16 v[112:115], v[76:79], v[72:75], v[112:115]
    ds_read_b128 v[72:75], v11 offset:64
    v_mfma_f32_16x16x32_bf16 v[108:111], v[76:79], v[68:71], v[108:111]
    v_mfma_f32_16x16x32_bf16 v[104:107], v[76:79], v[64:67], v[104:107]
    v_mfma_f32_16x16x32_bf16 v[100:103], v[76:79], v[60:63], v[100:103]
    ds_read_b64 v[76:77], v10 offset:3168
    ds_read_b64 v[78:79], v10 offset:3176
    s_waitcnt vmcnt(9)
    v_smfmac_f32_16x16x64_bf16 v[24:27], v[52:55], v[116:123], v2
    buffer_load_dwordx4 v[116:119], v4, s[36:39], s59 offen offset:2048 sc1
    buffer_load_dwordx4 v[120:123], v4, s[36:39], s59 offen offset:3072 sc1
    s_waitcnt lgkmcnt(3)
    v_mfma_f32_16x16x32_bf16 v[112:115], v[80:83], v[68:71], v[112:115]
    ds_read_b128 v[68:71], v11 offset:576
    v_mfma_f32_16x16x32_bf16 v[108:111], v[80:83], v[64:67], v[108:111]
    v_mfma_f32_16x16x32_bf16 v[104:107], v[80:83], v[60:63], v[104:107]
    ds_read_b64 v[80:81], v10 offset:3680
    ds_read_b64 v[82:83], v10 offset:3688
    s_waitcnt lgkmcnt(3)
    v_mfma_f32_16x16x32_bf16 v[112:115], v[76:79], v[64:67], v[112:115]
    ds_read_b128 v[64:67], v11 offset:1088
    s_waitcnt vmcnt(9)
    v_smfmac_f32_16x16x64_bf16 v[28:31], v[52:55], v[124:131], v2
    s_add_u32 s59, s11, 1572864
    buffer_load_dwordx4 v[124:127], v4, s[36:39], s59 offen offset:0 sc1
    buffer_load_dwordx4 v[128:131], v4, s[36:39], s59 offen offset:1024 sc1
    v_mfma_f32_16x16x32_bf16 v[108:111], v[76:79], v[60:63], v[108:111]
    ds_read_b64 v[76:77], v10 offset:96
    ds_read_b64 v[78:79], v10 offset:104
    s_waitcnt lgkmcnt(3)
    v_mfma_f32_16x16x32_bf16 v[112:115], v[80:83], v[60:63], v[112:115]
    ds_read_b128 v[60:63], v11 offset:1600
    ds_read_b64 v[80:81], v10 offset:608
    ds_read_b64 v[82:83], v10 offset:616
    s_waitcnt lgkmcnt(3)
    v_mfma_f32_16x16x32_bf16 v[112:115], v[76:79], v[72:75], v[112:115]
    ds_read_b128 v[72:75], v11 offset:2176
    v_mfma_f32_16x16x32_bf16 v[108:111], v[76:79], v[68:71], v[108:111]
    s_waitcnt vmcnt(9)
    v_smfmac_f32_16x16x64_bf16 v[32:35], v[52:55], v[132:139], v2
    buffer_load_dwordx4 v[132:135], v4, s[36:39], s59 offen offset:2048 sc1
    buffer_load_dwordx4 v[136:139], v4, s[36:39], s59 offen offset:3072 sc1
    v_mfma_f32_16x16x32_bf16 v[104:107], v[76:79], v[64:67], v[104:107]
    s_waitcnt lgkmcnt(3)
    v_mfma_f32_16x16x32_bf16 v[100:103], v[76:79], v[60:63], v[100:103]
    ds_read_b64 v[76:77], v10 offset:1120
    ds_read_b64 v[78:79], v10 offset:1128
    s_waitcnt lgkmcnt(3)
    v_mfma_f32_16x16x32_bf16 v[112:115], v[80:83], v[68:71], v[112:115]
    ds_read_b128 v[68:71], v11 offset:2688
    v_mfma_f32_16x16x32_bf16 v[108:111], v[80:83], v[64:67], v[108:111]
    s_waitcnt vmcnt(8)
    v_smfmac_f32_16x16x64_bf16 v[36:39], v[52:55], v[140:147], v2
    s_add_u32 s59, s11, 1576960
    buffer_load_dwordx4 v[140:143], v4, s[36:39], s59 offen offset:0 sc1
    buffer_load_dwordx4 v[144:147], v4, s[36:39], s59 offen offset:1024 sc1
    v_mfma_f32_16x16x32_bf16 v[104:107], v[80:83], v[60:63], v[104:107]
    ds_read_b64 v[80:81], v10 offset:1632
    ds_read_b64 v[82:83], v10 offset:1640
    s_waitcnt lgkmcnt(3)
    v_mfma_f32_16x16x32_bf16 v[112:115], v[76:79], v[64:67], v[112:115]
    ds_read_b128 v[64:67], v11 offset:3200
    v_mfma_f32_16x16x32_bf16 v[108:111], v[76:79], v[60:63], v[108:111]
    ds_read_b64 v[76:77], v10 offset:160
    ds_read_b64 v[78:79], v10 offset:168
    s_waitcnt lgkmcnt(3)
    v_mfma_f32_16x16x32_bf16 v[112:115], v[80:83], v[60:63], v[112:115]
    ds_read_b128 v[60:63], v11 offset:3712
    ds_read_b64 v[80:81], v10 offset:672
    ds_read_b64 v[82:83], v10 offset:680
    s_waitcnt vmcnt(8)
    v_smfmac_f32_16x16x64_bf16 v[40:43], v[52:55], v[148:155], v2
    buffer_load_dwordx4 v[148:151], v4, s[36:39], s59 offen offset:2048 sc1
    buffer_load_dwordx4 v[152:155], v4, s[36:39], s59 offen offset:3072 sc1
    s_waitcnt lgkmcnt(3)
    v_mfma_f32_16x16x32_bf16 v[96:99], v[76:79], v[72:75], v[96:99]
    v_mfma_f32_16x16x32_bf16 v[92:95], v[76:79], v[68:71], v[92:95]
    v_mfma_f32_16x16x32_bf16 v[88:91], v[76:79], v[64:67], v[88:91]
    s_waitcnt lgkmcnt(2)
    v_mfma_f32_16x16x32_bf16 v[84:87], v[76:79], v[60:63], v[84:87]
    s_waitcnt vmcnt(8)
    v_smfmac_f32_16x16x64_bf16 v[44:47], v[52:55], v[116:123], v2
    s_add_u32 s59, s11, 1581056
    buffer_load_dwordx4 v[116:119], v4, s[36:39], s59 offen offset:0 sc1
    buffer_load_dwordx4 v[120:123], v4, s[36:39], s59 offen offset:1024 sc1
    s_waitcnt lgkmcnt(0)
    v_mfma_f32_16x16x32_bf16 v[100:103], v[80:83], v[72:75], v[100:103]
    v_mfma_f32_16x16x32_bf16 v[96:99], v[80:83], v[68:71], v[96:99]
    v_mfma_f32_16x16x32_bf16 v[92:95], v[80:83], v[64:67], v[92:95]
    v_mfma_f32_16x16x32_bf16 v[88:91], v[80:83], v[60:63], v[88:91]
    s_waitcnt lgkmcnt(0)
    s_barrier
    s_mov_b64 exec, 0xffff
    buffer_load_dwordx4 v[156:159], v4, s[36:39], s69 offen offset:512 sc1
    s_mov_b64 exec, -1
    ds_read_b128 v[76:79], v4 offset:10240
    ds_read_b64 v[60:61], v5 offset:0
    ds_read_b64 v[62:63], v5 offset:2048
    ds_read_b64 v[64:65], v5 offset:4096
    ds_read_b64 v[66:67], v5 offset:6144
    ds_read_b64 v[68:69], v5 offset:8192
    ds_read_b64 v[70:71], v5 offset:10240
    ds_read_b64 v[72:73], v5 offset:12288
    ds_read_b64 v[74:75], v5 offset:14336
    s_waitcnt lgkmcnt(8)
    v_add_f32 v76, v76, v77
    v_add_f32 v78, v78, v79
    v_add_f32 v77, v76, v78
    v_add_f32 v76, v76, v78
    s_nop 1
    v_permlane32_swap_b32 v76, v77
    v_add_f32 v76, v76, v77
    v_rcp_f32 v78, v76
    s_nop 0
    v_max3_f32 v9, v9, v76, v78
    s_waitcnt lgkmcnt(0)
    v_add_f32 v60, v60, v62
    v_add_f32 v61, v61, v63
    v_add_f32 v60, v60, v64
    v_add_f32 v61, v61, v65
    v_add_f32 v60, v60, v66
    v_add_f32 v61, v61, v67
    v_add_f32 v60, v60, v68
    v_add_f32 v61, v61, v69
    v_add_f32 v60, v60, v70
    v_add_f32 v61, v61, v71
    v_add_f32 v60, v60, v72
    v_add_f32 v61, v61, v73
    v_add_f32 v60, v60, v74
    v_add_f32 v61, v61, v75
    v_mul_f32 v60, v60, v78
    v_mul_f32 v61, v61, v78
    v_cvt_pk_bf16_f32 v60, v60, v61
    ds_write_b32 v7, v60 offset:9216
    ds_read_b128 v[72:75], v11 offset:2176
    ds_read_b128 v[68:71], v11 offset:2688
    ds_read_b128 v[64:67], v11 offset:3200
    ds_read_b128 v[60:63], v11 offset:3712
    ds_read_b64 v[76:77], v10 offset:1184
    ds_read_b64 v[78:79], v10 offset:1192
    ds_read_b64 v[80:81], v10 offset:1696
    ds_read_b64 v[82:83], v10 offset:1704
    s_waitcnt lgkmcnt(2)
    v_mfma_f32_16x16x32_bf16 v[104:107], v[76:79], v[72:75], v[104:107]
    v_mfma_f32_16x16x32_bf16 v[100:103], v[76:79], v[68:71], v[100:103]
    v_mfma_f32_16x16x32_bf16 v[96:99], v[76:79], v[64:67], v[96:99]
    v_mfma_f32_16x16x32_bf16 v[92:95], v[76:79], v[60:63], v[92:95]
    ds_read_b64 v[76:77], v10 offset:2208
    ds_read_b64 v[78:79], v10 offset:2216
    s_waitcnt lgkmcnt(2)
    v_mfma_f32_16x16x32_bf16 v[108:111], v[80:83], v[72:75], v[108:111]
    v_mfma_f32_16x16x32_bf16 v[104:107], v[80:83], v[68:71], v[104:107]
    v_mfma_f32_16x16x32_bf16 v[100:103], v[80:83], v[64:67], v[100:103]
    v_mfma_f32_16x16x32_bf16 v[96:99], v[80:83], v[60:63], v[96:99]
    ds_read_b64 v[80:81], v10 offset:2720
    ds_read_b64 v[82:83], v10 offset:2728
    s_waitcnt lgkmcnt(2)
    v_mfma_f32_16x16x32_bf16 v[112:115], v[76:79], v[72:75], v[112:115]
    ds_read_b128 v[72:75], v11 offset:128
    v_mfma_f32_16x16x32_bf16 v[108:111], v[76:79], v[68:71], v[108:111]
    v_mfma_f32_16x16x32_bf16 v[104:107], v[76:79], v[64:67], v[104:107]
    v_mfma_f32_16x16x32_bf16 v[100:103], v[76:79], v[60:63], v[100:103]
    ds_read_b64 v[76:77], v10 offset:3232
    ds_read_b64 v[78:79], v10 offset:3240
    s_waitcnt lgkmcnt(3)
    v_mfma_f32_16x16x32_bf16 v[112:115], v[80:83], v[68:71], v[112:115]
    ds_read_b128 v[68:71], v11 offset:640
    v_mfma_f32_16x16x32_bf16 v[108:111], v[80:83], v[64:67], v[108:111]
    v_mfma_f32_16x16x32_bf16 v[104:107], v[80:83], v[60:63], v[104:107]
    ds_read_b64 v[80:81], v10 offset:3744
    ds_read_b64 v[82:83], v10 offset:3752
    s_waitcnt lgkmcnt(3)
    v_mfma_f32_16x16x32_bf16 v[112:115], v[76:79], v[64:67], v[112:115]
    ds_read_b128 v[64:67], v11 offset:1152
    v_mfma_f32_16x16x32_bf16 v[108:111], v[76:79], v[60:63], v[108:111]
    ds_read_b64 v[76:77], v10 offset:160
    ds_read_b64 v[78:79], v10 offset:168
    s_waitcnt lgkmcnt(3)
    v_mfma_f32_16x16x32_bf16 v[112:115], v[80:83], v[60:63], v[112:115]
    ds_read_b128 v[60:63], v11 offset:1664
    ds_read_b64 v[80:81], v10 offset:672
    ds_read_b64 v[82:83], v10 offset:680
    s_waitcnt lgkmcnt(3)
    v_mfma_f32_16x16x32_bf16 v[112:115], v[76:79], v[72:75], v[112:115]
    ds_read_b128 v[72:75], v11 offset:2240
    v_mfma_f32_16x16x32_bf16 v[108:111], v[76:79], v[68:71], v[108:111]
    v_mfma_f32_16x16x32_bf16 v[104:107], v[76:79], v[64:67], v[104:107]
    s_waitcnt lgkmcnt(3)
    v_mfma_f32_16x16x32_bf16 v[100:103], v[76:79], v[60:63], v[100:103]
    ds_read_b64 v[76:77], v10 offset:1184
    ds_read_b64 v[78:79], v10 offset:1192
    s_waitcnt lgkmcnt(3)
    v_mfma_f32_16x16x32_bf16 v[112:115], v[80:83], v[68:71], v[112:115]
    ds_read_b128 v[68:71], v11 offset:2752
    v_mfma_f32_16x16x32_bf16 v[108:111], v[80:83], v[64:67], v[108:111]
    v_mfma_f32_16x16x32_bf16 v[104:107], v[80:83], v[60:63], v[104:107]
    ds_read_b64 v[80:81], v10 offset:1696
    ds_read_b64 v[82:83], v10 offset:1704
    s_waitcnt lgkmcnt(3)
    v_mfma_f32_16x16x32_bf16 v[112:115], v[76:79], v[64:67], v[112:115]
    ds_read_b128 v[64:67], v11 offset:3264
    v_mfma_f32_16x16x32_bf16 v[108:111], v[76:79], v[60:63], v[108:111]
    ds_read_b64 v[76:77], v10 offset:224
    ds_read_b64 v[78:79], v10 offset:232
    s_waitcnt lgkmcnt(3)
    v_mfma_f32_16x16x32_bf16 v[112:115], v[80:83], v[60:63], v[112:115]
    ds_read_b128 v[60:63], v11 offset:3776
    ds_read_b64 v[80:81], v10 offset:736
    ds_read_b64 v[82:83], v10 offset:744
    s_waitcnt lgkmcnt(3)
    v_mfma_f32_16x16x32_bf16 v[96:99], v[76:79], v[72:75], v[96:99]
    v_mfma_f32_16x16x32_bf16 v[92:95], v[76:79], v[68:71], v[92:95]
    v_mfma_f32_16x16x32_bf16 v[88:91], v[76:79], v[64:67], v[88:91]
    s_waitcnt lgkmcnt(2)
    v_mfma_f32_16x16x32_bf16 v[84:87], v[76:79], v[60:63], v[84:87]
    ds_read_b64 v[76:77], v10 offset:1248
    ds_read_b64 v[78:79], v10 offset:1256
    s_waitcnt lgkmcnt(2)
    v_mfma_f32_16x16x32_bf16 v[100:103], v[80:83], v[72:75], v[100:103]
    v_mfma_f32_16x16x32_bf16 v[96:99], v[80:83], v[68:71], v[96:99]
    v_mfma_f32_16x16x32_bf16 v[92:95], v[80:83], v[64:67], v[92:95]
    v_mfma_f32_16x16x32_bf16 v[88:91], v[80:83], v[60:63], v[88:91]
    ds_read_b64 v[80:81], v10 offset:1760
    ds_read_b64 v[82:83], v10 offset:1768
    s_waitcnt lgkmcnt(2)
    v_mfma_f32_16x16x32_bf16 v[104:107], v[76:79], v[72:75], v[104:107]
    v_mfma_f32_16x16x32_bf16 v[100:103], v[76:79], v[68:71], v[100:103]
    v_mfma_f32_16x16x32_bf16 v[96:99], v[76:79], v[64:67], v[96:99]
    v_mfma_f32_16x16x32_bf16 v[92:95], v[76:79], v[60:63], v[92:95]
    ds_read_b64 v[76:77], v10 offset:2272
    ds_read_b64 v[78:79], v10 offset:2280
    s_mov_b64 exec, 0xffff
    s_waitcnt vmcnt(0)
    v_cmp_eq_u32 vcc, -1, v156
    s_cbranch_vccnz L_h_qx02
L_h_qb02:
    ds_write_b128 v166, v[156:159] offset:6144
    s_mov_b64 exec, -1
    s_waitcnt lgkmcnt(0)
    s_barrier
    ds_read2st64_b32 v[52:53], v167 offset0:36 offset1:37
    ds_read2st64_b32 v[54:55], v167 offset0:38 offset1:39
    v_mfma_f32_16x16x32_bf16 v[108:111], v[80:83], v[72:75], v[108:111]
    v_mfma_f32_16x16x32_bf16 v[104:107], v[80:83], v[68:71], v[104:107]
    s_waitcnt lgkmcnt(0)
    v_smfmac_f32_16x16x64_bf16 v[16:19], v[52:55], v[124:131], v2
    buffer_load_dwordx4 v[124:127], v4, s[36:39], s59 offen offset:2048 sc1
    buffer_load_dwordx4 v[128:131], v4, s[36:39], s59 offen offset:3072 sc1
    v_mfma_f32_16x16x32_bf16 v[100:103], v[80:83], v[64:67], v[100:103]
    v_mfma_f32_16x16x32_bf16 v[96:99], v[80:83], v[60:63], v[96:99]
    ds_read_b64 v[80:81], v10 offset:2784
    ds_read_b64 v[82:83], v10 offset:2792
    v_smfmac_f32_16x16x64_bf16 v[20:23], v[52:55], v[132:139], v2
    s_add_u32 s59, s11, 1585152
    buffer_load_dwordx4 v[132:135], v4, s[36:39], s59 offen offset:0 sc1
    buffer_load_dwordx4 v[136:139], v4, s[36:39], s59 offen offset:1024 sc1
    v_mfma_f32_16x16x32_bf16 v[112:115], v[76:79], v[72:75], v[112:115]
    ds_read_b128 v[72:75], v11 offset:192
    v_mfma_f32_16x16x32_bf16 v[108:111], v[76:79], v[68:71], v[108:111]
    v_smfmac_f32_16x16x64_bf16 v[24:27], v[52:55], v[140:147], v2
    buffer_load_dwordx4 v[140:143], v4, s[36:39], s59 offen offset:2048 sc1
    buffer_load_dwordx4 v[144:147], v4, s[36:39], s59 offen offset:3072 sc1
    v_mfma_f32_16x16x32_bf16 v[104:107], v[76:79], v[64:67], v[104:107]
    v_mfma_f32_16x16x32_bf16 v[100:103], v[76:79], v[60:63], v[100:103]
    ds_read_b64 v[76:77], v10 offset:3296
    ds_read_b64 v[78:79], v10 offset:3304
    v_smfmac_f32_16x16x64_bf16 v[28:31], v[52:55], v[148:155], v2
    s_add_u32 s59, s14, 1048576
    buffer_load_dwordx4 v[148:151], v4, s[36:39], s59 offen offset:0 sc1
    buffer_load_dwordx4 v[152:155], v4, s[36:39], s59 offen offset:1024 sc1
    s_waitcnt lgkmcnt(3)
    v_mfma_f32_16x16x32_bf16 v[112:115], v[80:83], v[68:71], v[112:115]
    ds_read_b128 v[68:71], v11 offset:704
    v_mfma_f32_16x16x32_bf16 v[108:111], v[80:83], v[64:67], v[108:111]
    v_smfmac_f32_16x16x64_bf16 v[32:35], v[52:55], v[116:123], v2
    buffer_load_dwordx4 v[116:119], v4, s[36:39], s59 offen offset:2048 sc1
    buffer_load_dwordx4 v[120:123], v4, s[36:39], s59 offen offset:3072 sc1
    v_mfma_f32_16x16x32_bf16 v[104:107], v[80:83], v[60:63], v[104:107]
    ds_read_b64 v[80:81], v10 offset:3808
    ds_read_b64 v[82:83], v10 offset:3816
    s_waitcnt lgkmcnt(3)
    v_mfma_f32_16x16x32_bf16 v[112:115], v[76:79], v[64:67], v[112:115]
    ds_read_b128 v[64:67], v11 offset:1216
    s_waitcnt vmcnt(8)
    v_smfmac_f32_16x16x64_bf16 v[36:39], v[52:55], v[124:131], v2
    s_add_u32 s59, s14, 1052672
    buffer_load_dwordx4 v[124:127], v4, s[36:39], s59 offen offset:0 sc1
    buffer_load_dwordx4 v[128:131], v4, s[36:39], s59 offen offset:1024 sc1
    v_mfma_f32_16x16x32_bf16 v[108:111], v[76:79], v[60:63], v[108:111]
    ds_read_b64 v[76:77], v10 offset:224
    ds_read_b64 v[78:79], v10 offset:232
    s_waitcnt lgkmcnt(3)
    v_mfma_f32_16x16x32_bf16 v[112:115], v[80:83], v[60:63], v[112:115]
    ds_read_b128 v[60:63], v11 offset:1728
    ds_read_b64 v[80:81], v10 offset:736
    ds_read_b64 v[82:83], v10 offset:744
    s_waitcnt vmcnt(8)
    v_smfmac_f32_16x16x64_bf16 v[40:43], v[52:55], v[132:139], v2
    buffer_load_dwordx4 v[132:135], v4, s[36:39], s59 offen offset:2048 sc1
    buffer_load_dwordx4 v[136:139], v4, s[36:39], s59 offen offset:3072 sc1
    s_waitcnt lgkmcnt(3)
    v_mfma_f32_16x16x32_bf16 v[112:115], v[76:79], v[72:75], v[112:115]
    v_mfma_f32_16x16x32_bf16 v[108:111], v[76:79], v[68:71], v[108:111]
    s_waitcnt vmcnt(8)
    v_smfmac_f32_16x16x64_bf16 v[44:47], v[52:55], v[140:147], v2
    s_add_u32 s59, s14, 1056768
    buffer_load_dwordx4 v[140:143], v4, s[36:39], s59 offen offset:0 sc1
    buffer_load_dwordx4 v[144:147], v4, s[36:39], s59 offen offset:1024 sc1
    v_mfma_f32_16x16x32_bf16 v[104:107], v[76:79], v[64:67], v[104:107]
    s_waitcnt lgkmcnt(2)
    v_mfma_f32_16x16x32_bf16 v[100:103], v[76:79], v[60:63], v[100:103]
    ds_read_b64 v[76:77], v10 offset:1248
    ds_read_b64 v[78:79], v10 offset:1256
    ds_read_b128 v[48:51], v15
    ds_read_b128 v[156:159], v15
    ds_read_b128 v[52:55], v3 offset:12288
    ds_read_b128 v[56:59], v3 offset:20480
    s_waitcnt lgkmcnt(6)
    v_mfma_f32_16x16x32_bf16 v[112:115], v[80:83], v[68:71], v[112:115]
    v_mfma_f32_16x16x32_bf16 v[108:111], v[80:83], v[64:67], v[108:111]
    ds_read_b128 v[160:163], v3 offset:13312
    s_waitcnt lgkmcnt(2) vmcnt(8)
    v_smfmac_f32_16x16x64_bf16 v[48:51], v[52:55], v[148:155], v2
    ds_read_b128 v[52:55], v3 offset:21504
    s_waitcnt lgkmcnt(2)
    v_smfmac_f32_16x16x64_bf16 v[156:159], v[56:59], v[148:155], v2
    buffer_load_dwordx4 v[148:151], v4, s[36:39], s59 offen offset:2048 sc1
    buffer_load_dwordx4 v[152:155], v4, s[36:39], s59 offen offset:3072 sc1
    v_mfma_f32_16x16x32_bf16 v[104:107], v[80:83], v[60:63], v[104:107]
    ds_read_b64 v[80:81], v10 offset:1760
    ds_read_b64 v[82:83], v10 offset:1768
    v_mfma_f32_16x16x32_bf16 v[112:115], v[76:79], v[64:67], v[112:115]
    ds_read_b128 v[56:59], v3 offset:14336
    s_waitcnt vmcnt(8) lgkmcnt(4)
    v_smfmac_f32_16x16x64_bf16 v[48:51], v[160:163], v[116:123], v2
    ds_read_b128 v[160:163], v3 offset:22528
    s_waitcnt lgkmcnt(4)
    v_smfmac_f32_16x16x64_bf16 v[156:159], v[52:55], v[116:123], v2
    s_add_u32 s59, s14, 1060864
    buffer_load_dwordx4 v[116:119], v4, s[36:39], s59 offen offset:0 sc1
    buffer_load_dwordx4 v[120:123], v4, s[36:39], s59 offen offset:1024 sc1
    v_mfma_f32_16x16x32_bf16 v[108:111], v[76:79], v[60:63], v[108:111]
    s_waitcnt lgkmcnt(2)
    v_mfma_f32_16x16x32_bf16 v[112:115], v[80:83], v[60:63], v[112:115]
    v_add_u32 v164, s75, v4
    s_nop 7
    s_nop 3
    s_waitcnt lgkmcnt(0)
    s_cmp_eq_u32 s71, 0
    s_cbranch_scc1 L_h_s0
    ds_write_b128 v164, v[84:87] offset:0
    ds_write_b128 v164, v[88:91] offset:1024
    ds_write_b128 v164, v[92:95] offset:2048
    ds_write_b128 v164, v[96:99] offset:3072
    s_branch L_h_s1
L_h_s0:
    ds_write_b128 v164, v[100:103] offset:0
    ds_write_b128 v164, v[104:107] offset:1024
    ds_write_b128 v164, v[108:111] offset:2048
    ds_write_b128 v164, v[112:115] offset:3072
L_h_s1:
    s_waitcnt lgkmcnt(0)
    s_waitcnt lgkmcnt(0)
    s_barrier
    ds_read_b128 v[76:79], v4 offset:10240
    ds_read_b64 v[60:61], v5 offset:0
    ds_read_b64 v[62:63], v5 offset:2048
    ds_read_b64 v[64:65], v5 offset:4096
    ds_read_b64 v[66:67], v5 offset:6144
    ds_read_b64 v[68:69], v5 offset:8192
    ds_read_b64 v[70:71], v5 offset:10240
    ds_read_b64 v[72:73], v5 offset:12288
    ds_read_b64 v[74:75], v5 offset:14336
    s_waitcnt lgkmcnt(8)
    v_add_f32 v76, v76, v77
    v_add_f32 v78, v78, v79
    v_add_f32 v77, v76, v78
    v_add_f32 v76, v76, v78
    s_nop 1
    v_permlane32_swap_b32 v76, v77
    v_add_f32 v76, v76, v77
    v_rcp_f32 v78, v76
    s_nop 0
    v_max3_f32 v9, v9, v76, v78
    s_waitcnt lgkmcnt(0)
    v_add_f32 v60, v60, v62
    v_add_f32 v61, v61, v63
    v_add_f32 v60, v60, v64
    v_add_f32 v61, v61, v65
    v_add_f32 v60, v60, v66
    v_add_f32 v61, v61, v67
    v_add_f32 v60, v60, v68
    v_add_f32 v61, v61, v69
    v_add_f32 v60, v60, v70
    v_add_f32 v61, v61, v71
    v_add_f32 v60, v60, v72
    v_add_f32 v61, v61, v73
    v_add_f32 v60, v60, v74
    v_add_f32 v61, v61, v75
    v_mul_f32 v60, v60, v78
    v_mul_f32 v61, v61, v78
    v_cvt_pk_bf16_f32 v60, v60, v61
    ds_write_b32 v7, v60 offset:9216
    ds_read_b128 v[52:55], v3 offset:15360
    s_waitcnt vmcnt(8)
    v_smfmac_f32_16x16x64_bf16 v[48:51], v[56:59], v[124:131], v2
    ds_read_b128 v[56:59], v3 offset:23552
    v_smfmac_f32_16x16x64_bf16 v[156:159], v[160:163], v[124:131], v2
    buffer_load_dwordx4 v[124:127], v4, s[36:39], s59 offen offset:2048 sc1
    buffer_load_dwordx4 v[128:131], v4, s[36:39], s59 offen offset:3072 sc1
    s_xor_b32 s82, s56, 1
    s_lshl_b32 s82, s82, 12
    s_add_u32 s82, s82, 77824
    v_add_u32 v164, s82, v4
    ds_read_b128 v[60:63], v164 offset:0
    ds_read_b128 v[64:67], v164 offset:1024
    ds_read_b128 v[68:71], v164 offset:2048
    ds_read_b128 v[72:75], v164 offset:3072
    v_lshrrev_b32 v14, 4, v0
    v_and_b32 v164, 0xf0, v4
    v_lshlrev_b32 v164, 1, v164
    v_lshl_add_u32 v14, v14, 3, v164
    s_lshl_b32 s7, s71, 11
    s_sub_u32 s7, s76, s7
    s_add_u32 s7, s7, 2552
    v_sub_u32 v164, s7, v14
    ds_read_b64 v[76:77], v164 offset:1536
    ds_read_b64 v[78:79], v164 offset:1024
    ds_read_b64 v[80:81], v164 offset:512
    ds_read_b64 v[82:83], v164 offset:0
    ds_read_b128 v[160:163], v3 offset:16384
    s_waitcnt lgkmcnt(10) vmcnt(8)
    v_smfmac_f32_16x16x64_bf16 v[48:51], v[52:55], v[132:139], v2
    ds_read_b128 v[52:55], v3 offset:24576
    s_waitcnt lgkmcnt(10)
    v_smfmac_f32_16x16x64_bf16 v[156:159], v[56:59], v[132:139], v2
    s_add_u32 s59, s12, 1572864
    buffer_load_dwordx4 v[132:135], v4, s[36:39], s59 offen offset:0 sc1
    buffer_load_dwordx4 v[136:139], v4, s[36:39], s59 offen offset:1024 sc1
    s_setprio 3
    s_waitcnt lgkmcnt(0)
    s_cmp_eq_u32 s71, 0
    s_cbranch_scc1 L_h_f0
    v_add_f32 v60, v60, v100
    v_add_f32 v61, v61, v101
    v_add_f32 v62, v62, v102
    v_add_f32 v63, v63, v103
    v_add_f32 v64, v64, v104
    v_add_f32 v65, v65, v105
    v_add_f32 v66, v66, v106
    v_add_f32 v67, v67, v107
    v_add_f32 v68, v68, v108
    v_add_f32 v69, v69, v109
    v_add_f32 v70, v70, v110
    v_add_f32 v71, v71, v111
    v_add_f32 v72, v72, v112
    v_add_f32 v73, v73, v113
    v_add_f32 v74, v74, v114
    v_add_f32 v75, v75, v115
    s_branch L_h_f1
L_h_f0:
    v_add_f32 v60, v60, v84
    v_add_f32 v61, v61, v85
    v_add_f32 v62, v62, v86
    v_add_f32 v63, v63, v87
    v_add_f32 v64, v64, v88
    v_add_f32 v65, v65, v89
    v_add_f32 v66, v66, v90
    v_add_f32 v67, v67, v91
    v_add_f32 v68, v68, v92
    v_add_f32 v69, v69, v93
    v_add_f32 v70, v70, v94
    v_add_f32 v71, v71, v95
    v_add_f32 v72, v72, v96
    v_add_f32 v73, v73, v97
    v_add_f32 v74, v74, v98
    v_add_f32 v75, v75, v99
L_h_f1:
    v_add_u32 v164, s82, v14
    ds_read_b128 v[56:59], v3 offset:17408
    s_waitcnt vmcnt(8)
    v_smfmac_f32_16x16x64_bf16 v[48:51], v[160:163], v[140:147], v2
    ds_read_b128 v[160:163], v3 offset:25600
    v_smfmac_f32_16x16x64_bf16 v[156:159], v[52:55], v[140:147], v2
    buffer_load_dwordx4 v[140:143], v4, s[36:39], s59 offen offset:2048 sc1
    buffer_load_dwordx4 v[144:147], v4, s[36:39], s59 offen offset:3072 sc1
    v_and_b32 v165, 0xffff0000, v77
    v_fmac_f32 v60, s58, v165
    v_lshlrev_b32 v165, 16, v77
    v_fmac_f32 v61, s58, v165
    v_and_b32 v165, 0xffff0000, v76
    v_fmac_f32 v62, s58, v165
    v_lshlrev_b32 v165, 16, v76
    v_fmac_f32 v63, s58, v165
    v_cvt_pk_bf16_f32 v60, v60, v61
    v_cvt_pk_bf16_f32 v61, v62, v63
    ds_write_b64 v164, v[60:61] offset:0
    ds_read_b128 v[52:55], v3 offset:18432
    s_waitcnt lgkmcnt(3) vmcnt(8)
    v_smfmac_f32_16x16x64_bf16 v[48:51], v[56:59], v[148:155], v2
    ds_read_b128 v[56:59], v3 offset:26624
    s_waitcnt lgkmcnt(3)
    v_smfmac_f32_16x16x64_bf16 v[156:159], v[160:163], v[148:155], v2
    s_add_u32 s59, s12, 1576960
    buffer_load_dwordx4 v[148:151], v4, s[36:39], s59 offen offset:0 sc1
    buffer_load_dwordx4 v[152:155], v4, s[36:39], s59 offen offset:1024 sc1
    v_and_b32 v165, 0xffff0000, v79
    v_fmac_f32 v64, s58, v165
    v_lshlrev_b32 v165, 16, v79
    v_fmac_f32 v65, s58, v165
    v_and_b32 v165, 0xffff0000, v78
    v_fmac_f32 v66, s58, v165
    v_lshlrev_b32 v165, 16, v78
    v_fmac_f32 v67, s58, v165
    v_cvt_pk_bf16_f32 v64, v64, v65
    v_cvt_pk_bf16_f32 v65, v66, v67
    ds_write_b64 v164, v[64:65] offset:512
    ds_read_b128 v[160:163], v3 offset:19456
    s_waitcnt lgkmcnt(3) vmcnt(8)
    v_smfmac_f32_16x16x64_bf16 v[48:51], v[52:55], v[116:123], v2
    ds_read_b128 v[52:55], v3 offset:27648
    s_waitcnt lgkmcnt(3)
    v_smfmac_f32_16x16x64_bf16 v[156:159], v[56:59], v[116:123], v2
    buffer_load_dwordx4 v[116:119], v4, s[36:39], s59 offen offset:2048 sc1
    buffer_load_dwordx4 v[120:123], v4, s[36:39], s59 offen offset:3072 sc1
    v_and_b32 v165, 0xffff0000, v81
    v_fmac_f32 v68, s58, v165
    v_lshlrev_b32 v165, 16, v81
    v_fmac_f32 v69, s58, v165
    v_and_b32 v165, 0xffff0000, v80
    v_fmac_f32 v70, s58, v165
    v_lshlrev_b32 v165, 16, v80
    v_fmac_f32 v71, s58, v165
    v_cvt_pk_bf16_f32 v68, v68, v69
    v_cvt_pk_bf16_f32 v69, v70, v71
    ds_write_b64 v164, v[68:69] offset:1024
    s_waitcnt vmcnt(8) lgkmcnt(2)
    v_smfmac_f32_16x16x64_bf16 v[48:51], v[160:163], v[124:131], v2
    s_waitcnt lgkmcnt(1)
    v_smfmac_f32_16x16x64_bf16 v[156:159], v[52:55], v[124:131], v2
    s_add_u32 s59, s12, 1581056
    buffer_load_dwordx4 v[124:127], v4, s[36:39], s59 offen offset:0 sc1
    buffer_load_dwordx4 v[128:131], v4, s[36:39], s59 offen offset:1024 sc1
    v_and_b32 v165, 0xffff0000, v83
    v_fmac_f32 v72, s58, v165
    v_lshlrev_b32 v165, 16, v83
    v_fmac_f32 v73, s58, v165
    v_and_b32 v165, 0xffff0000, v82
    v_fmac_f32 v74, s58, v165
    v_lshlrev_b32 v165, 16, v82
    v_fmac_f32 v75, s58, v165
    v_cvt_pk_bf16_f32 v72, v72, v73
    v_cvt_pk_bf16_f32 v73, v74, v75
    ds_write_b64 v164, v[72:73] offset:1536
    v_add_f32 v12, v48, v49
    v_add_f32 v13, v50, v51
    v_cvt_pk_bf16_f32 v12, v12, v13
    ds_write_b16 v1, v12 offset:7168
    ds_write_b16_d16_hi v1, v12 offset:7184
    v_add_u32 v164, s82, v4
    ds_read_b128 v[60:63], v164
    ds_read_b128 v[64:67], v164 offset:1024
    v_add_f32 v12, v156, v157
    v_add_f32 v13, v158, v159
    v_cvt_pk_bf16_f32 v12, v12, v13
    ds_write_b16 v1, v12 offset:11264
    ds_write_b16_d16_hi v1, v12 offset:11280
    s_mov_b64 exec, 0xffff
    ds_read_b128 v[156:159], v166 offset:11264
    s_waitcnt lgkmcnt(0)
    buffer_store_dwordx4 v[156:159], v4, s[36:39], s68 offen offset:768 sc1
    s_mov_b64 exec, -1
    s_lshr_b32 s6, s72, 3
    s_lshl_b32 s6, s6, 7
    s_lshl_b32 s7, s72, 12
    s_add_u32 s6, s6, s7
    s_lshl_b32 s7, s71, 11
    s_add_u32 s6, s6, s7
    s_add_u32 s6, s6, 4325376
    buffer_store_dwordx4 v[60:63], v4, s[36:39], s6 offen sc1
    buffer_store_dwordx4 v[64:67], v4, s[36:39], s6 offen offset:1024 sc1
    s_waitcnt lgkmcnt(0)
    s_barrier
    ds_read2st64_b32 v[52:53], v167 offset0:36 offset1:37
    ds_read2st64_b32 v[54:55], v167 offset0:38 offset1:39
    s_waitcnt lgkmcnt(0) vmcnt(11)
    v_smfmac_f32_16x16x64_bf16 v[16:19], v[52:55], v[132:139], v2
    buffer_load_dwordx4 v[84:87], v4, s[36:39], s59 offen offset:2048 sc1
    buffer_load_dwordx4 v[88:91], v4, s[36:39], s59 offen offset:3072 sc1
    s_add_u32 s59, s12, 1585152
    buffer_load_dwordx4 v[92:95], v4, s[36:39], s59 offen offset:0 sc1
    buffer_load_dwordx4 v[96:99], v4, s[36:39], s59 offen offset:1024 sc1
    buffer_load_dwordx4 v[132:135], v4, s[36:39], s59 offen offset:2048 sc1
    buffer_load_dwordx4 v[136:139], v4, s[36:39], s59 offen offset:3072 sc1
    s_waitcnt vmcnt(15)
    v_smfmac_f32_16x16x64_bf16 v[20:23], v[52:55], v[140:147], v2
    s_add_u32 s59, s13, 1572864
    buffer_load_dwordx4 v[140:143], v4, s[36:39], s59 offen offset:0 sc1
    buffer_load_dwordx4 v[144:147], v4, s[36:39], s59 offen offset:1024 sc1
    s_waitcnt vmcnt(15)
    v_smfmac_f32_16x16x64_bf16 v[24:27], v[52:55], v[148:155], v2
    buffer_load_dwordx4 v[148:151], v4, s[36:39], s59 offen offset:2048 sc1
    buffer_load_dwordx4 v[152:155], v4, s[36:39], s59 offen offset:3072 sc1
    s_waitcnt vmcnt(10)
    s_and_b32 s6, s72, 7
    s_lshl_b32 s6, s6, 11
    s_lshr_b32 s7, s72, 3
    s_lshl_b32 s7, s7, 5
    s_add_u32 s6, s6, s7
    s_lshl_b32 s7, s71, 14
    s_add_u32 s6, s6, s7
    s_add_u32 s6, s6, 360448
    v_mov_b32 v68, s5
    v_mov_b32 v69, s5
    v_mov_b32 v70, s5
    v_mov_b32 v71, s5
    s_mov_b64 exec, 3
    buffer_store_dwordx4 v[68:71], v4, s[36:39], s6 offen sc1
    s_mov_b64 exec, -1
    v_smfmac_f32_16x16x64_bf16 v[28:31], v[52:55], v[116:123], v2
    s_add_u32 s59, s13, 1576960
    buffer_load_dwordx4 v[116:119], v4, s[36:39], s59 offen offset:0 sc1
    buffer_load_dwordx4 v[120:123], v4, s[36:39], s59 offen offset:1024 sc1
    v_smfmac_f32_16x16x64_bf16 v[32:35], v[52:55], v[124:131], v2
    buffer_load_dwordx4 v[124:127], v4, s[36:39], s59 offen offset:2048 sc1
    buffer_load_dwordx4 v[128:131], v4, s[36:39], s59 offen offset:3072 sc1
    s_waitcnt vmcnt(13)
    v_smfmac_f32_16x16x64_bf16 v[36:39], v[52:55], v[84:91], v2
    s_add_u32 s59, s13, 1581056
    buffer_load_dwordx4 v[84:87], v4, s[36:39], s59 offen offset:0 sc1
    buffer_load_dwordx4 v[88:91], v4, s[36:39], s59 offen offset:1024 sc1
    s_waitcnt vmcnt(13)
    v_smfmac_f32_16x16x64_bf16 v[40:43], v[52:55], v[92:99], v2
    buffer_load_dwordx4 v[92:95], v4, s[36:39], s59 offen offset:2048 sc1
    buffer_load_dwordx4 v[96:99], v4, s[36:39], s59 offen offset:3072 sc1
    s_waitcnt vmcnt(13)
    v_smfmac_f32_16x16x64_bf16 v[44:47], v[52:55], v[132:139], v2
    s_add_u32 s59, s13, 1585152
    buffer_load_dwordx4 v[132:135], v4, s[36:39], s59 offen offset:0 sc1
    buffer_load_dwordx4 v[136:139], v4, s[36:39], s59 offen offset:1024 sc1
    s_waitcnt lgkmcnt(0)
    s_barrier
    s_mov_b64 exec, 0xffff
    buffer_load_dwordx4 v[156:159], v4, s[36:39], s69 offen offset:768 sc1
    s_mov_b64 exec, -1
    ds_read_b128 v[76:79], v4 offset:10240
    ds_read_b64 v[60:61], v5 offset:0
    ds_read_b64 v[62:63], v5 offset:2048
    ds_read_b64 v[64:65], v5 offset:4096
    ds_read_b64 v[66:67], v5 offset:6144
    ds_read_b64 v[68:69], v5 offset:8192
    ds_read_b64 v[70:71], v5 offset:10240
    ds_read_b64 v[72:73], v5 offset:12288
    ds_read_b64 v[74:75], v5 offset:14336
    s_waitcnt lgkmcnt(8)
    v_add_f32 v76, v76, v77
    v_add_f32 v78, v78, v79
    v_add_f32 v77, v76, v78
    v_add_f32 v76, v76, v78
    s_nop 1
    v_permlane32_swap_b32 v76, v77
    v_add_f32 v76, v76, v77
    v_rcp_f32 v78, v76
    s_nop 0
    v_max3_f32 v9, v9, v76, v78
    s_waitcnt lgkmcnt(0)
    v_add_f32 v60, v60, v62
    v_add_f32 v61, v61, v63
    v_add_f32 v60, v60, v64
    v_add_f32 v61, v61, v65
    v_add_f32 v60, v60, v66
    v_add_f32 v61, v61, v67
    v_add_f32 v60, v60, v68
    v_add_f32 v61, v61, v69
    v_add_f32 v60, v60, v70
    v_add_f32 v61, v61, v71
    v_add_f32 v60, v60, v72
    v_add_f32 v61, v61, v73
    v_add_f32 v60, v60, v74
    v_add_f32 v61, v61, v75
    v_mul_f32 v60, v60, v78
    v_mul_f32 v61, v61, v78
    v_cvt_pk_bf16_f32 v60, v60, v61
    ds_write_b32 v7, v60 offset:9216
    s_mov_b64 exec, 0xffff
    s_waitcnt vmcnt(0)
    v_cmp_eq_u32 vcc, -1, v156
    s_cbranch_vccnz L_h_qx03
L_h_qb03:
    ds_write_b128 v166, v[156:159] offset:8192
    s_mov_b64 exec, -1
    s_waitcnt lgkmcnt(0)
    buffer_load_dwordx4 v[100:103], v4, s[36:39], s59 offen offset:2048 sc1
    buffer_load_dwordx4 v[104:107], v4, s[36:39], s59 offen offset:3072 sc1
    s_add_u32 s59, s14, 1572864
    buffer_load_dwordx4 v[108:111], v4, s[36:39], s59 offen offset:0 sc1
    buffer_load_dwordx4 v[112:115], v4, s[36:39], s59 offen offset:1024 sc1
    buffer_load_dwordx4 v[156:159], v4, s[36:39], s59 offen offset:2048 sc1
    buffer_load_dwordx4 v[160:163], v4, s[36:39], s59 offen offset:3072 sc1
    s_waitcnt lgkmcnt(0)
    s_barrier
    s_lshr_b32 s6, s4, 7
    s_lshl_b32 s6, s6, 14
    s_lshl_b32 s7, s56, 12
    s_add_u32 s6, s6, s7
    s_add_u32 s79, s6, 360448
    v_lshlrev_b32 v165, 5, v0
    buffer_load_dword v164, v165, s[36:39], s79 offen sc1
    buffer_load_dword v165, v165, s[36:39], s79 offen offset:2048 sc1
    ds_read2st64_b32 v[52:53], v167 offset0:36 offset1:37
    ds_read2st64_b32 v[54:55], v167 offset0:38 offset1:39
    s_waitcnt lgkmcnt(0)
    v_smfmac_f32_16x16x64_bf16 v[16:19], v[52:55], v[140:147], v2
    s_add_u32 s59, s14, 1576960
    buffer_load_dwordx4 v[140:143], v4, s[36:39], s59 offen offset:0 sc1
    buffer_load_dwordx4 v[144:147], v4, s[36:39], s59 offen offset:1024 sc1
    v_smfmac_f32_16x16x64_bf16 v[20:23], v[52:55], v[148:155], v2
    buffer_load_dwordx4 v[148:151], v4, s[36:39], s59 offen offset:2048 sc1
    buffer_load_dwordx4 v[152:155], v4, s[36:39], s59 offen offset:3072 sc1
    v_smfmac_f32_16x16x64_bf16 v[24:27], v[52:55], v[116:123], v2
    s_add_u32 s59, s14, 1581056
    buffer_load_dwordx4 v[116:119], v4, s[36:39], s59 offen offset:0 sc1
    buffer_load_dwordx4 v[120:123], v4, s[36:39], s59 offen offset:1024 sc1
    v_smfmac_f32_16x16x64_bf16 v[28:31], v[52:55], v[124:131], v2
    buffer_load_dwordx4 v[124:127], v4, s[36:39], s59 offen offset:2048 sc1
    buffer_load_dwordx4 v[128:131], v4, s[36:39], s59 offen offset:3072 sc1
    v_smfmac_f32_16x16x64_bf16 v[32:35], v[52:55], v[84:91], v2
    s_add_u32 s59, s14, 1585152
    buffer_load_dwordx4 v[84:87], v4, s[36:39], s59 offen offset:0 sc1
    buffer_load_dwordx4 v[88:91], v4, s[36:39], s59 offen offset:1024 sc1
    v_smfmac_f32_16x16x64_bf16 v[36:39], v[52:55], v[92:99], v2
    buffer_load_dwordx4 v[92:95], v4, s[36:39], s59 offen offset:2048 sc1
    buffer_load_dwordx4 v[96:99], v4, s[36:39], s59 offen offset:3072 sc1
    v_smfmac_f32_16x16x64_bf16 v[40:43], v[52:55], v[132:139], v2
    s_add_u32 s59, s15, 1572864
    buffer_load_dwordx4 v[132:135], v4, s[36:39], s59 offen offset:0 sc1
    buffer_load_dwordx4 v[136:139], v4, s[36:39], s59 offen offset:1024 sc1
    s_waitcnt vmcnt(20)
    v_smfmac_f32_16x16x64_bf16 v[44:47], v[52:55], v[100:107], v2
    buffer_load_dwordx4 v[100:103], v4, s[36:39], s59 offen offset:2048 sc1
    buffer_load_dwordx4 v[104:107], v4, s[36:39], s59 offen offset:3072 sc1
    s_waitcnt vmcnt(17)
    v_cmp_ne_u32 vcc, s5, v164
    s_waitcnt vmcnt(16)
    v_cmp_ne_u32 s[6:7], s5, v165
    s_nop 0
    s_or_b64 vcc, vcc, s[6:7]
    s_cbranch_vccnz L_h_fy_slow
L_h_fy_back:
    v_mul_u32_u24 v165, 32896, v0
    s_lshl_b32 s6, s56, 13
    s_lshl_b32 s7, s4, 4
    s_add_u32 s6, s6, s7
    s_add_u32 s6, s6, 4325376
    s_add_u32 s80, s6, 4096
    buffer_load_dwordx4 v[48:51], v165, s[36:39], s6 offen sc1
    s_waitcnt lgkmcnt(0)
    s_barrier
    ds_read_b128 v[76:79], v4 offset:10240
    ds_read_b64 v[60:61], v5 offset:0
    ds_read_b64 v[62:63], v5 offset:2048
    ds_read_b64 v[64:65], v5 offset:4096
    ds_read_b64 v[66:67], v5 offset:6144
    ds_read_b64 v[68:69], v5 offset:8192
    ds_read_b64 v[70:71], v5 offset:10240
    ds_read_b64 v[72:73], v5 offset:12288
    ds_read_b64 v[74:75], v5 offset:14336
    s_waitcnt lgkmcnt(8)
    v_add_f32 v76, v76, v77
    v_add_f32 v78, v78, v79
    v_add_f32 v77, v76, v78
    v_add_f32 v76, v76, v78
    s_nop 1
    v_permlane32_swap_b32 v76, v77
    v_add_f32 v76, v76, v77
    v_rcp_f32 v78, v76
    s_nop 0
    v_max3_f32 v9, v9, v76, v78
    s_waitcnt lgkmcnt(0)
    v_add_f32 v60, v60, v62
    v_add_f32 v61, v61, v63
    v_add_f32 v60, v60, v64
    v_add_f32 v61, v61, v65
    v_add_f32 v60, v60, v66
    v_add_f32 v61, v61, v67
    v_add_f32 v60, v60, v68
    v_add_f32 v61, v61, v69
    v_add_f32 v60, v60, v70
    v_add_f32 v61, v61, v71
    v_add_f32 v60, v60, v72
    v_add_f32 v61, v61, v73
    v_add_f32 v60, v60, v74
    v_add_f32 v61, v61, v75
    v_mul_f32 v60, v60, v78
    v_mul_f32 v61, v61, v78
    v_cvt_pk_bf16_f32 v60, v60, v61
    ds_write_b32 v7, v60 offset:9216
    buffer_load_dwordx4 v[56:59], v165, s[36:39], s80 offen sc1
    s_waitcnt lgkmcnt(0)
    s_barrier
    ds_read2st64_b32 v[52:53], v167 offset0:36 offset1:37
    ds_read2st64_b32 v[54:55], v167 offset0:38 offset1:39
    s_waitcnt lgkmcnt(0)
    v_smfmac_f32_16x16x64_bf16 v[16:19], v[52:55], v[108:115], v2
    s_add_u32 s59, s15, 1576960
    buffer_load_dwordx4 v[108:111], v4, s[36:39], s59 offen offset:0 sc1
    buffer_load_dwordx4 v[112:115], v4, s[36:39], s59 offen offset:1024 sc1
    v_smfmac_f32_16x16x64_bf16 v[20:23], v[52:55], v[156:163], v2
    buffer_load_dwordx4 v[156:159], v4, s[36:39], s59 offen offset:2048 sc1
    buffer_load_dwordx4 v[160:163], v4, s[36:39], s59 offen offset:3072 sc1
    s_waitcnt vmcnt(20)
    v_smfmac_f32_16x16x64_bf16 v[24:27], v[52:55], v[140:147], v2
    s_add_u32 s59, s15, 1581056
    buffer_load_dwordx4 v[140:143], v4, s[36:39], s59 offen offset:0 sc1
    buffer_load_dwordx4 v[144:147], v4, s[36:39], s59 offen offset:1024 sc1
    s_waitcnt vmcnt(20)
    v_smfmac_f32_16x16x64_bf16 v[28:31], v[52:55], v[148:155], v2
    buffer_load_dwordx4 v[148:151], v4, s[36:39], s59 offen offset:2048 sc1
    buffer_load_dwordx4 v[152:155], v4, s[36:39], s59 offen offset:3072 sc1
    s_waitcnt vmcnt(20)
    v_smfmac_f32_16x16x64_bf16 v[32:35], v[52:55], v[116:123], v2
    s_add_u32 s59, s15, 1585152
    buffer_load_dwordx4 v[116:119], v4, s[36:39], s59 offen offset:0 sc1
    buffer_load_dwordx4 v[120:123], v4, s[36:39], s59 offen offset:1024 sc1
    s_waitcnt vmcnt(20)
    v_smfmac_f32_16x16x64_bf16 v[36:39], v[52:55], v[124:131], v2
    buffer_load_dwordx4 v[124:127], v4, s[36:39], s59 offen offset:2048 sc1
    buffer_load_dwordx4 v[128:131], v4, s[36:39], s59 offen offset:3072 sc1
    s_waitcnt vmcnt(20)
    v_smfmac_f32_16x16x64_bf16 v[40:43], v[52:55], v[84:91], v2
    s_add_u32 s59, s9, 1048576
    buffer_load_dwordx4 v[84:87], v4, s[36:39], s59 offen offset:0 sc1
    buffer_load_dwordx4 v[88:91], v4, s[36:39], s59 offen offset:1024 sc1
    s_waitcnt vmcnt(20)
    v_smfmac_f32_16x16x64_bf16 v[44:47], v[52:55], v[92:99], v2
    buffer_load_dwordx4 v[92:95], v4, s[36:39], s59 offen offset:2048 sc1
    buffer_load_dwordx4 v[96:99], v4, s[36:39], s59 offen offset:3072 sc1
    s_mov_b32 s6, 0x05040100
    s_mov_b32 s7, 0x07060302
    v_add_u32 v164, s74, v4
    s_waitcnt vmcnt(16)
    v_perm_b32 v60, v56, v48, s6
    ds_write_b32 v164, v60 offset:20480
    v_perm_b32 v61, v56, v48, s7
    ds_write_b32 v164, v61 offset:21504
    v_perm_b32 v62, v57, v49, s6
    ds_write_b32 v164, v62 offset:22528
    v_perm_b32 v63, v57, v49, s7
    ds_write_b32 v164, v63 offset:23552
    v_perm_b32 v64, v58, v50, s6
    ds_write_b32 v164, v64 offset:24576
    v_perm_b32 v65, v58, v50, s7
    ds_write_b32 v164, v65 offset:25600
    v_perm_b32 v66, v59, v51, s6
    ds_write_b32 v164, v66 offset:26624
    v_perm_b32 v67, v59, v51, s7
    ds_write_b32 v164, v67 offset:27648
    v_lshrrev_b32 v12, 4, v0
    v_and_b32 v13, 15, v0
    v_lshlrev_b32 v13, 3, v13
    v_lshl_add_u32 v12, v12, 12, v13
    s_lshl_b32 s6, s56, 7
    s_add_u32 s6, s6, 28672
    v_add_u32 v12, s6, v12
    s_waitcnt lgkmcnt(0)
    s_barrier
    s_setprio 3
    ds_read_b128 v[76:79], v6 offset:10240
    ds_read_b128 v[80:83], v6 offset:10752
    ds_read_b64 v[60:61], v5 offset:0
    ds_read_b64 v[62:63], v5 offset:2048
    ds_read_b64 v[64:65], v5 offset:4096
    ds_read_b64 v[66:67], v5 offset:6144
    ds_read_b64 v[68:69], v5 offset:8192
    ds_read_b64 v[70:71], v5 offset:10240
    ds_read_b64 v[72:73], v5 offset:12288
    ds_read_b64 v[74:75], v5 offset:14336
    s_waitcnt lgkmcnt(8)
    v_pk_add_f32 v[80:81], v[80:81], v[82:83]
    v_pk_add_f32 v[76:77], v[76:77], v[78:79]
    v_pk_add_f32 v[76:77], v[76:77], v[80:81]
    v_add_f32 v76, v76, v77
    v_rcp_f32 v78, v76
    s_nop 0
    v_max3_f32 v9, v9, v76, v78
    v_cmp_ngt_f32 vcc, 1400897536, v9
    s_nop 0
    s_or_b32 s84, vcc_lo, vcc_hi
    v_mov_b32 v13, s84
    ds_write_b32 v15, v13 offset:80
    s_waitcnt lgkmcnt(5)
    v_pk_add_f32 v[64:65], v[64:65], v[66:67]
    v_pk_add_f32 v[60:61], v[60:61], v[62:63]
    v_pk_add_f32 v[60:61], v[60:61], v[64:65]
    s_waitcnt lgkmcnt(1)
    v_pk_add_f32 v[72:73], v[72:73], v[74:75]
    v_pk_add_f32 v[68:69], v[68:69], v[70:71]
    v_pk_add_f32 v[60:61], v[60:61], v[72:73]
    v_pk_add_f32 v[60:61], v[60:61], v[68:69]
    v_pk_mul_f32 v[60:61], v[60:61], v[78:79] op_sel_hi:[1,0]
    v_cvt_pk_bf16_f32 v60, v60, v61
    ds_write_b32 v7, v60 offset:9216
    s_waitcnt vmcnt(4)
    s_waitcnt lgkmcnt(0)
    s_barrier
    s_cmp_lg_u32 s84, 0
    s_cbranch_scc1 L_h_exact0
L_h_rejoin0:
    ds_read2st64_b32 v[52:53], v167 offset0:36 offset1:37
    ds_read2st64_b32 v[54:55], v167 offset0:38 offset1:39
    s_waitcnt lgkmcnt(0)
    v_smfmac_f32_16x16x64_bf16 v[16:19], v[52:55], v[132:139], v2
    v_smfmac_f32_16x16x64_bf16 v[20:23], v[52:55], v[100:107], v2
    v_smfmac_f32_16x16x64_bf16 v[24:27], v[52:55], v[108:115], v2
    v_smfmac_f32_16x16x64_bf16 v[28:31], v[52:55], v[156:163], v2
    v_smfmac_f32_16x16x64_bf16 v[32:35], v[52:55], v[140:147], v2
    v_add_f32 v60, v16, v17
    v_add_f32 v68, v18, v19
    v_smfmac_f32_16x16x64_bf16 v[36:39], v[52:55], v[148:155], v2
    v_add_f32 v61, v20, v21
    v_add_f32 v69, v22, v23
    ds_write_b64 v12, v[60:61] offset:0
    ds_write_b64 v12, v[68:69] offset:2048
    v_smfmac_f32_16x16x64_bf16 v[40:43], v[52:55], v[116:123], v2
    v_add_f32 v62, v24, v25
    v_add_f32 v70, v26, v27
    v_smfmac_f32_16x16x64_bf16 v[44:47], v[52:55], v[124:131], v2
    v_add_f32 v63, v28, v29
    v_add_f32 v71, v30, v31
    ds_write_b64 v12, v[62:63] offset:512
    ds_write_b64 v12, v[70:71] offset:2560
    v_add_f32 v64, v32, v33
    v_add_f32 v72, v34, v35
    v_add_f32 v65, v36, v37
    v_add_f32 v73, v38, v39
    ds_write_b64 v12, v[64:65] offset:1024
    ds_write_b64 v12, v[72:73] offset:3072
    v_add_f32 v66, v40, v41
    v_add_f32 v74, v42, v43
    v_add_f32 v67, v44, v45
    v_add_f32 v75, v46, v47
    ds_write_b64 v12, v[66:67] offset:1536
    ds_write_b64 v12, v[74:75] offset:3584
    s_waitcnt lgkmcnt(0)
    s_barrier
    s_setprio 2
    s_cmp_lg_u32 s56, 0
    s_cbranch_scc1 L_h_nohint0
L_h_nohint0:
    s_add_u32 s59, s9, 1052672
    buffer_load_dwordx4 v[132:135], v4, s[36:39], s59 offen offset:0 sc1
    buffer_load_dwordx4 v[136:139], v4, s[36:39], s59 offen offset:1024 sc1
    buffer_load_dwordx4 v[100:103], v4, s[36:39], s59 offen offset:2048 sc1
    buffer_load_dwordx4 v[104:107], v4, s[36:39], s59 offen offset:3072 sc1
    s_add_u32 s59, s9, 1056768
    buffer_load_dwordx4 v[108:111], v4, s[36:39], s59 offen offset:0 sc1
    buffer_load_dwordx4 v[112:115], v4, s[36:39], s59 offen offset:1024 sc1
    buffer_load_dwordx4 v[156:159], v4, s[36:39], s59 offen offset:2048 sc1
    buffer_load_dwordx4 v[160:163], v4, s[36:39], s59 offen offset:3072 sc1
    s_add_u32 s59, s9, 1060864
    buffer_load_dwordx4 v[140:143], v4, s[36:39], s59 offen offset:0 sc1
    buffer_load_dwordx4 v[144:147], v4, s[36:39], s59 offen offset:1024 sc1
    s_barrier
    buffer_load_dwordx4 v[148:151], v4, s[36:39], s59 offen offset:2048 sc1
    buffer_load_dwordx4 v[152:155], v4, s[36:39], s59 offen offset:3072 sc1
    v_mov_b64 v[16:17], 0
    v_mov_b64 v[18:19], 0
    v_mov_b64 v[20:21], 0
    v_mov_b64 v[22:23], 0
    v_mov_b64 v[24:25], 0
    v_mov_b64 v[26:27], 0
    v_mov_b64 v[28:29], 0
    v_mov_b64 v[30:31], 0
    v_mov_b64 v[32:33], 0
    v_mov_b64 v[34:35], 0
    v_mov_b64 v[36:37], 0
    v_mov_b64 v[38:39], 0
    v_mov_b64 v[40:41], 0
    v_mov_b64 v[42:43], 0
    v_mov_b64 v[44:45], 0
    v_mov_b64 v[46:47], 0
    ds_read_b128 v[48:51], v15
    ds_read_b128 v[52:55], v3 offset:12288
    ds_read_b128 v[56:59], v3 offset:13312
    s_waitcnt vmcnt(14) lgkmcnt(1)
    v_smfmac_f32_16x16x64_bf16 v[48:51], v[52:55], v[84:91], v2
    ds_read_b128 v[52:55], v3 offset:14336
    s_waitcnt lgkmcnt(1) vmcnt(12)
    v_smfmac_f32_16x16x64_bf16 v[48:51], v[56:59], v[92:99], v2
    ds_read_b128 v[56:59], v3 offset:15360
    s_waitcnt lgkmcnt(1) vmcnt(10)
    v_smfmac_f32_16x16x64_bf16 v[48:51], v[52:55], v[132:139], v2
    ds_read_b128 v[52:55], v3 offset:16384
    s_waitcnt lgkmcnt(1) vmcnt(8)
    v_smfmac_f32_16x16x64_bf16 v[48:51], v[56:59], v[100:107], v2
    ds_read_b128 v[56:59], v3 offset:17408
    s_waitcnt vmcnt(6) lgkmcnt(1)
    v_smfmac_f32_16x16x64_bf16 v[48:51], v[52:55], v[108:115], v2
    ds_read_b128 v[52:55], v3 offset:18432
    s_waitcnt lgkmcnt(1) vmcnt(4)
    v_smfmac_f32_16x16x64_bf16 v[48:51], v[56:59], v[156:163], v2
    ds_read_b128 v[56:59], v3 offset:19456
    s_waitcnt vmcnt(2) lgkmcnt(1)
    v_smfmac_f32_16x16x64_bf16 v[48:51], v[52:55], v[140:147], v2
    s_waitcnt lgkmcnt(0) vmcnt(0)
    v_smfmac_f32_16x16x64_bf16 v[48:51], v[56:59], v[148:155], v2
    s_nop 7
    v_add_f32 v12, v48, v49
    v_add_f32 v13, v50, v51
    v_cvt_pk_bf16_f32 v12, v12, v13
    ds_write_b16 v1, v12 offset:2048
    ds_write_b16_d16_hi v1, v12 offset:2064
    v_mov_b32 v12, 2
    v_mov_b32 v13, s74
    ds_write_b32 v13, v12 offset:64
    s_waitcnt lgkmcnt(0)
    s_barrier
    s_add_u32 s68, s68, 1048576
    s_add_u32 s69, s69, 1048576
    v_lshrrev_b32 v68, 3, v0
    v_and_b32 v69, 0x70, v4
    v_lshl_add_u32 v70, v68, 10, v69
    s_lshl_b32 s6, s4, 13
    s_lshl_b32 s7, s56, 8
    s_add_u32 s6, s6, s7
    s_add_u32 s80, s6, 8650752
    s_xor_b32 s80, s80, 8192
    s_setprio 3
    v_bfe_u32 v69, v0, 1, 2
    v_xor_b32 v68, v68, v69
    v_lshlrev_b32 v68, 5, v68
    v_lshl_add_u32 v68, v69, 8, v68
    v_and_b32 v69, 16, v4
    s_lshl_b32 s6, s56, 11
    v_add3_u32 v68, v68, v69, s6
    s_mov_b32 s78, 20000
    s_sleep 24
L_h_xg:
    s_sleep 6
    buffer_load_dwordx4 v[60:63], v70, s[36:39], s80 offen sc1
    buffer_load_dwordx4 v[64:67], v70, s[36:39], s80 offen offset:128 sc1
    s_waitcnt vmcnt(0)
    v_max_u32 v69, v60, v64
    v_cmp_eq_u32 vcc, -1, v69
    s_cbranch_vccz L_h_xgok
    s_sub_u32 s78, s78, 1
    s_cmp_gt_i32 s78, 0
    s_cbranch_scc1 L_h_xg
L_h_xgok:
    ds_write_b128 v68, v[60:63] offset:45056
    ds_write_b128 v68, v[64:67] offset:46080
    s_waitcnt lgkmcnt(0)
    s_barrier
    s_setprio 3
    s_add_u32 s59, s10, 1048576
    buffer_load_dwordx4 v[116:119], v4, s[36:39], s59 offen offset:0 sc1
    buffer_load_dwordx4 v[120:123], v4, s[36:39], s59 offen offset:1024 sc1
    buffer_load_dwordx4 v[124:127], v4, s[36:39], s59 offen offset:2048 sc1
    buffer_load_dwordx4 v[128:131], v4, s[36:39], s59 offen offset:3072 sc1
    s_add_u32 s59, s10, 1052672
    buffer_load_dwordx4 v[84:87], v4, s[36:39], s59 offen offset:0 sc1
    buffer_load_dwordx4 v[88:91], v4, s[36:39], s59 offen offset:1024 sc1
    buffer_load_dwordx4 v[92:95], v4, s[36:39], s59 offen offset:2048 sc1
    buffer_load_dwordx4 v[96:99], v4, s[36:39], s59 offen offset:3072 sc1
    s_add_u32 s59, s10, 1056768
    buffer_load_dwordx4 v[132:135], v4, s[36:39], s59 offen offset:0 sc1
    buffer_load_dwordx4 v[136:139], v4, s[36:39], s59 offen offset:1024 sc1
    buffer_load_dwordx4 v[100:103], v4, s[36:39], s59 offen offset:2048 sc1
    buffer_load_dwordx4 v[104:107], v4, s[36:39], s59 offen offset:3072 sc1
    s_add_u32 s59, s10, 1060864
    buffer_load_dwordx4 v[108:111], v4, s[36:39], s59 offen offset:0 sc1
    buffer_load_dwordx4 v[112:115], v4, s[36:39], s59 offen offset:1024 sc1
    buffer_load_dwordx4 v[140:143], v4, s[36:39], s59 offen offset:2048 sc1
    buffer_load_dwordx4 v[144:147], v4, s[36:39], s59 offen offset:3072 sc1
    s_add_u32 s59, s8, 1572864
    buffer_load_dwordx4 v[148:151], v4, s[36:39], s59 offen offset:0 sc1
    buffer_load_dwordx4 v[152:155], v4, s[36:39], s59 offen offset:1024 sc1
    ds_read_b128 v[48:51], v15
    ds_read_b128 v[156:159], v15
    ds_read_b128 v[52:55], v3 offset:12288
    ds_read_b128 v[56:59], v3 offset:45056
    ds_read_b128 v[160:163], v3 offset:13312
    s_waitcnt lgkmcnt(2) vmcnt(16)
    v_smfmac_f32_16x16x64_bf16 v[48:51], v[52:55], v[116:123], v2
    ds_read_b128 v[52:55], v3 offset:46080
    s_waitcnt lgkmcnt(2)
    v_smfmac_f32_16x16x64_bf16 v[156:159], v[56:59], v[116:123], v2
    buffer_load_dwordx4 v[116:119], v4, s[36:39], s59 offen offset:2048 sc1
    buffer_load_dwordx4 v[120:123], v4, s[36:39], s59 offen offset:3072 sc1
    ds_read_b128 v[56:59], v3 offset:14336
    s_waitcnt vmcnt(16) lgkmcnt(2)
    v_smfmac_f32_16x16x64_bf16 v[48:51], v[160:163], v[124:131], v2
    ds_read_b128 v[160:163], v3 offset:47104
    s_waitcnt lgkmcnt(2)
    v_smfmac_f32_16x16x64_bf16 v[156:159], v[52:55], v[124:131], v2
    s_add_u32 s59, s8, 1576960
    buffer_load_dwordx4 v[124:127], v4, s[36:39], s59 offen offset:0 sc1
    buffer_load_dwordx4 v[128:131], v4, s[36:39], s59 offen offset:1024 sc1
    s_waitcnt lgkmcnt(0)
    s_barrier
    ds_read_b128 v[76:79], v4 offset:10240
    ds_read_b64 v[60:61], v5 offset:0
    ds_read_b64 v[62:63], v5 offset:2048
    ds_read_b64 v[64:65], v5 offset:4096
    ds_read_b64 v[66:67], v5 offset:6144
    ds_read_b64 v[68:69], v5 offset:8192
    ds_read_b64 v[70:71], v5 offset:10240
    ds_read_b64 v[72:73], v5 offset:12288
    ds_read_b64 v[74:75], v5 offset:14336
    s_waitcnt lgkmcnt(8)
    v_add_f32 v76, v76, v77
    v_add_f32 v78, v78, v79
    v_add_f32 v77, v76, v78
    v_add_f32 v76, v76, v78
    s_nop 1
    v_permlane32_swap_b32 v76, v77
    v_add_f32 v76, v76, v77
    v_rcp_f32 v78, v76
    s_nop 0
    v_max_f32 v9, v76, v78
    s_waitcnt lgkmcnt(0)
    v_add_f32 v60, v60, v62
    v_add_f32 v61, v61, v63
    v_add_f32 v60, v60, v64
    v_add_f32 v61, v61, v65
    v_add_f32 v60, v60, v66
    v_add_f32 v61, v61, v67
    v_add_f32 v60, v60, v68
    v_add_f32 v61, v61, v69
    v_add_f32 v60, v60, v70
    v_add_f32 v61, v61, v71
    v_add_f32 v60, v60, v72
    v_add_f32 v61, v61, v73
    v_add_f32 v60, v60, v74
    v_add_f32 v61, v61, v75
    v_mul_f32 v60, v60, v78
    v_mul_f32 v61, v61, v78
    v_cvt_pk_bf16_f32 v60, v60, v61
    ds_write_b32 v7, v60 offset:9216
    ds_read_b128 v[52:55], v3 offset:15360
    s_waitcnt vmcnt(16)
    v_smfmac_f32_16x16x64_bf16 v[48:51], v[56:59], v[84:91], v2
    ds_read_b128 v[56:59], v3 offset:48128
    v_smfmac_f32_16x16x64_bf16 v[156:159], v[160:163], v[84:91], v2
    buffer_load_dwordx4 v[84:87], v4, s[36:39], s59 offen offset:2048 sc1
    buffer_load_dwordx4 v[88:91], v4, s[36:39], s59 offen offset:3072 sc1
    ds_read_b128 v[160:163], v3 offset:16384
    s_waitcnt lgkmcnt(2) vmcnt(16)
    v_smfmac_f32_16x16x64_bf16 v[48:51], v[52:55], v[92:99], v2
    ds_read_b128 v[52:55], v3 offset:49152
    s_waitcnt lgkmcnt(2)
    v_smfmac_f32_16x16x64_bf16 v[156:159], v[56:59], v[92:99], v2
    s_add_u32 s59, s8, 1581056
    buffer_load_dwordx4 v[92:95], v4, s[36:39], s59 offen offset:0 sc1
    buffer_load_dwordx4 v[96:99], v4, s[36:39], s59 offen offset:1024 sc1
    ds_read_b128 v[56:59], v3 offset:17408
    s_waitcnt vmcnt(16) lgkmcnt(2)
    v_smfmac_f32_16x16x64_bf16 v[48:51], v[160:163], v[132:139], v2
    ds_read_b128 v[160:163], v3 offset:50176
    s_waitcnt lgkmcnt(2)
    v_smfmac_f32_16x16x64_bf16 v[156:159], v[52:55], v[132:139], v2
    buffer_load_dwordx4 v[132:135], v4, s[36:39], s59 offen offset:2048 sc1
    buffer_load_dwordx4 v[136:139], v4, s[36:39], s59 offen offset:3072 sc1
    ds_read_b128 v[52:55], v3 offset:18432
    s_waitcnt lgkmcnt(2) vmcnt(16)
    v_smfmac_f32_16x16x64_bf16 v[48:51], v[56:59], v[100:107], v2
    ds_read_b128 v[56:59], v3 offset:51200
    s_waitcnt lgkmcnt(2)
    v_smfmac_f32_16x16x64_bf16 v[156:159], v[160:163], v[100:107], v2
    s_add_u32 s59, s8, 1585152
    buffer_load_dwordx4 v[100:103], v4, s[36:39], s59 offen offset:0 sc1
    buffer_load_dwordx4 v[104:107], v4, s[36:39], s59 offen offset:1024 sc1
    ds_read_b128 v[160:163], v3 offset:19456
    s_waitcnt vmcnt(16) lgkmcnt(2)
    v_smfmac_f32_16x16x64_bf16 v[48:51], v[52:55], v[108:115], v2
    ds_read_b128 v[52:55], v3 offset:52224
    s_waitcnt lgkmcnt(2)
    v_smfmac_f32_16x16x64_bf16 v[156:159], v[56:59], v[108:115], v2
    buffer_load_dwordx4 v[108:111], v4, s[36:39], s59 offen offset:2048 sc1
    buffer_load_dwordx4 v[112:115], v4, s[36:39], s59 offen offset:3072 sc1
    s_waitcnt vmcnt(16) lgkmcnt(1)
    v_smfmac_f32_16x16x64_bf16 v[48:51], v[160:163], v[140:147], v2
    s_waitcnt lgkmcnt(0)
    v_smfmac_f32_16x16x64_bf16 v[156:159], v[52:55], v[140:147], v2
    s_add_u32 s59, s9, 1572864
    buffer_load_dwordx4 v[140:143], v4, s[36:39], s59 offen offset:0 sc1
    buffer_load_dwordx4 v[144:147], v4, s[36:39], s59 offen offset:1024 sc1
    s_nop 0
    v_add_f32 v12, v48, v49
    v_add_f32 v13, v50, v51
    v_cvt_pk_bf16_f32 v12, v12, v13
    ds_write_b16 v1, v12 offset:3072
    ds_write_b16_d16_hi v1, v12 offset:3088
    v_add_f32 v12, v156, v157
    v_add_f32 v13, v158, v159
    v_cvt_pk_bf16_f32 v12, v12, v13
    ds_write_b16 v1, v12 offset:11264
    ds_write_b16_d16_hi v1, v12 offset:11280
    s_mov_b64 exec, 0xffff
    ds_read_b128 v[156:159], v166 offset:11264
    s_waitcnt lgkmcnt(0)
    buffer_store_dwordx4 v[156:159], v4, s[36:39], s68 offen offset:256 sc1
    s_mov_b64 exec, -1
    s_waitcnt lgkmcnt(0)
    s_barrier
    ds_read2st64_b32 v[52:53], v167 offset0:36 offset1:37
    ds_read2st64_b32 v[54:55], v167 offset0:38 offset1:39
    s_waitcnt lgkmcnt(0) vmcnt(17)
    v_smfmac_f32_16x16x64_bf16 v[16:19], v[52:55], v[148:155], v2
    buffer_load_dwordx4 v[148:151], v4, s[36:39], s59 offen offset:2048 sc1
    buffer_load_dwordx4 v[152:155], v4, s[36:39], s59 offen offset:3072 sc1
    s_waitcnt vmcnt(17)
    v_smfmac_f32_16x16x64_bf16 v[20:23], v[52:55], v[116:123], v2
    s_add_u32 s59, s9, 1576960
    buffer_load_dwordx4 v[116:119], v4, s[36:39], s59 offen offset:0 sc1
    buffer_load_dwordx4 v[120:123], v4, s[36:39], s59 offen offset:1024 sc1
    s_waitcnt vmcnt(17)
    v_smfmac_f32_16x16x64_bf16 v[24:27], v[52:55], v[124:131], v2
    buffer_load_dwordx4 v[124:127], v4, s[36:39], s59 offen offset:2048 sc1
    buffer_load_dwordx4 v[128:131], v4, s[36:39], s59 offen offset:3072 sc1
    s_waitcnt vmcnt(17)
    v_smfmac_f32_16x16x64_bf16 v[28:31], v[52:55], v[84:91], v2
    s_add_u32 s59, s9, 1581056
    buffer_load_dwordx4 v[84:87], v4, s[36:39], s59 offen offset:0 sc1
    buffer_load_dwordx4 v[88:91], v4, s[36:39], s59 offen offset:1024 sc1
    s_waitcnt vmcnt(17)
    v_smfmac_f32_16x16x64_bf16 v[32:35], v[52:55], v[92:99], v2
    buffer_load_dwordx4 v[92:95], v4, s[36:39], s59 offen offset:2048 sc1
    buffer_load_dwordx4 v[96:99], v4, s[36:39], s59 offen offset:3072 sc1
    s_waitcnt vmcnt(17)
    v_smfmac_f32_16x16x64_bf16 v[36:39], v[52:55], v[132:139], v2
    s_add_u32 s59, s9, 1585152
    buffer_load_dwordx4 v[132:135], v4, s[36:39], s59 offen offset:0 sc1
    buffer_load_dwordx4 v[136:139], v4, s[36:39], s59 offen offset:1024 sc1
    s_waitcnt vmcnt(17)
    v_smfmac_f32_16x16x64_bf16 v[40:43], v[52:55], v[100:107], v2
    buffer_load_dwordx4 v[100:103], v4, s[36:39], s59 offen offset:2048 sc1
    buffer_load_dwordx4 v[104:107], v4, s[36:39], s59 offen offset:3072 sc1
    s_waitcnt vmcnt(17)
    v_smfmac_f32_16x16x64_bf16 v[44:47], v[52:55], v[108:115], v2
    s_add_u32 s59, s12, 1048576
    buffer_load_dwordx4 v[108:111], v4, s[36:39], s59 offen offset:0 sc1
    buffer_load_dwordx4 v[112:115], v4, s[36:39], s59 offen offset:1024 sc1
    s_waitcnt lgkmcnt(0)
    s_barrier
    s_mov_b64 exec, 0xffff
    buffer_load_dwordx4 v[156:159], v4, s[36:39], s69 offen offset:256 sc1
    s_mov_b64 exec, -1
    ds_read_b128 v[76:79], v4 offset:10240
    ds_read_b64 v[60:61], v5 offset:0
    ds_read_b64 v[62:63], v5 offset:2048
    ds_read_b64 v[64:65], v5 offset:4096
    ds_read_b64 v[66:67], v5 offset:6144
    ds_read_b64 v[68:69], v5 offset:8192
    ds_read_b64 v[70:71], v5 offset:10240
    ds_read_b64 v[72:73], v5 offset:12288
    ds_read_b64 v[74:75], v5 offset:14336
    s_waitcnt lgkmcnt(8)
    v_add_f32 v76, v76, v77
    v_add_f32 v78, v78, v79
    v_add_f32 v77, v76, v78
    v_add_f32 v76, v76, v78
    s_nop 1
    v_permlane32_swap_b32 v76, v77
    v_add_f32 v76, v76, v77
    v_rcp_f32 v78, v76
    s_nop 0
    v_max3_f32 v9, v9, v76, v78
    s_waitcnt lgkmcnt(0)
    v_add_f32 v60, v60, v62
    v_add_f32 v61, v61, v63
    v_add_f32 v60, v60, v64
    v_add_f32 v61, v61, v65
    v_add_f32 v60, v60, v66
    v_add_f32 v61, v61, v67
    v_add_f32 v60, v60, v68
    v_add_f32 v61, v61, v69
    v_add_f32 v60, v60, v70
    v_add_f32 v61, v61, v71
    v_add_f32 v60, v60, v72
    v_add_f32 v61, v61, v73
    v_add_f32 v60, v60, v74
    v_add_f32 v61, v61, v75
    v_mul_f32 v60, v60, v78
    v_mul_f32 v61, v61, v78
    v_cvt_pk_bf16_f32 v60, v60, v61
    ds_write_b32 v7, v60 offset:9216
    s_mov_b64 exec, 0xffff
    s_waitcnt vmcnt(0)
    v_cmp_eq_u32 vcc, -1, v156
    s_cbranch_vccnz L_h_qx11
L_h_qb11:
    ds_write_b128 v166, v[156:159] offset:4096
    s_mov_b64 exec, -1
    s_waitcnt lgkmcnt(0)
    s_barrier
    ds_read2st64_b32 v[52:53], v167 offset0:36 offset1:37
    ds_read2st64_b32 v[54:55], v167 offset0:38 offset1:39
    s_waitcnt lgkmcnt(0)
    v_smfmac_f32_16x16x64_bf16 v[16:19], v[52:55], v[140:147], v2
    buffer_load_dwordx4 v[140:143], v4, s[36:39], s59 offen offset:2048 sc1
    buffer_load_dwordx4 v[144:147], v4, s[36:39], s59 offen offset:3072 sc1
    v_smfmac_f32_16x16x64_bf16 v[20:23], v[52:55], v[148:155], v2
    s_add_u32 s59, s12, 1052672
    buffer_load_dwordx4 v[148:151], v4, s[36:39], s59 offen offset:0 sc1
    buffer_load_dwordx4 v[152:155], v4, s[36:39], s59 offen offset:1024 sc1
    v_smfmac_f32_16x16x64_bf16 v[24:27], v[52:55], v[116:123], v2
    buffer_load_dwordx4 v[116:119], v4, s[36:39], s59 offen offset:2048 sc1
    buffer_load_dwordx4 v[120:123], v4, s[36:39], s59 offen offset:3072 sc1
    v_smfmac_f32_16x16x64_bf16 v[28:31], v[52:55], v[124:131], v2
    s_add_u32 s59, s12, 1056768
    buffer_load_dwordx4 v[124:127], v4, s[36:39], s59 offen offset:0 sc1
    buffer_load_dwordx4 v[128:131], v4, s[36:39], s59 offen offset:1024 sc1
    v_smfmac_f32_16x16x64_bf16 v[32:35], v[52:55], v[84:91], v2
    buffer_load_dwordx4 v[84:87], v4, s[36:39], s59 offen offset:2048 sc1
    buffer_load_dwordx4 v[88:91], v4, s[36:39], s59 offen offset:3072 sc1
    v_smfmac_f32_16x16x64_bf16 v[36:39], v[52:55], v[92:99], v2
    s_add_u32 s59, s12, 1060864
    buffer_load_dwordx4 v[92:95], v4, s[36:39], s59 offen offset:0 sc1
    buffer_load_dwordx4 v[96:99], v4, s[36:39], s59 offen offset:1024 sc1
    v_smfmac_f32_16x16x64_bf16 v[40:43], v[52:55], v[132:139], v2
    buffer_load_dwordx4 v[132:135], v4, s[36:39], s59 offen offset:2048 sc1
    buffer_load_dwordx4 v[136:139], v4, s[36:39], s59 offen offset:3072 sc1
    v_smfmac_f32_16x16x64_bf16 v[44:47], v[52:55], v[100:107], v2
    s_add_u32 s59, s10, 1572864
    buffer_load_dwordx4 v[100:103], v4, s[36:39], s59 offen offset:0 sc1
    buffer_load_dwordx4 v[104:107], v4, s[36:39], s59 offen offset:1024 sc1
    ds_read_b128 v[48:51], v15
    ds_read_b128 v[156:159], v15
    ds_read_b128 v[52:55], v3 offset:12288
    ds_read_b128 v[56:59], v3 offset:45056
    ds_read_b128 v[160:163], v3 offset:13312
    s_waitcnt lgkmcnt(2)
    v_smfmac_f32_16x16x64_bf16 v[48:51], v[52:55], v[108:115], v2
    ds_read_b128 v[52:55], v3 offset:46080
    s_waitcnt lgkmcnt(2)
    v_smfmac_f32_16x16x64_bf16 v[156:159], v[56:59], v[108:115], v2
    buffer_load_dwordx4 v[108:111], v4, s[36:39], s59 offen offset:2048 sc1
    buffer_load_dwordx4 v[112:115], v4, s[36:39], s59 offen offset:3072 sc1
    ds_read_b128 v[56:59], v3 offset:14336
    s_waitcnt vmcnt(16) lgkmcnt(2)
    v_smfmac_f32_16x16x64_bf16 v[48:51], v[160:163], v[140:147], v2
    ds_read_b128 v[160:163], v3 offset:47104
    s_waitcnt lgkmcnt(2)
    v_smfmac_f32_16x16x64_bf16 v[156:159], v[52:55], v[140:147], v2
    s_add_u32 s59, s10, 1576960
    buffer_load_dwordx4 v[140:143], v4, s[36:39], s59 offen offset:0 sc1
    buffer_load_dwordx4 v[144:147], v4, s[36:39], s59 offen offset:1024 sc1
    s_waitcnt lgkmcnt(0)
    s_barrier
    ds_read_b128 v[76:79], v4 offset:10240
    ds_read_b64 v[60:61], v5 offset:0
    ds_read_b64 v[62:63], v5 offset:2048
    ds_read_b64 v[64:65], v5 offset:4096
    ds_read_b64 v[66:67], v5 offset:6144
    ds_read_b64 v[68:69], v5 offset:8192
    ds_read_b64 v[70:71], v5 offset:10240
    ds_read_b64 v[72:73], v5 offset:12288
    ds_read_b64 v[74:75], v5 offset:14336
    s_waitcnt lgkmcnt(8)
    v_add_f32 v76, v76, v77
    v_add_f32 v78, v78, v79
    v_add_f32 v77, v76, v78
    v_add_f32 v76, v76, v78
    s_nop 1
    v_permlane32_swap_b32 v76, v77
    v_add_f32 v76, v76, v77
    v_rcp_f32 v78, v76
    s_nop 0
    v_max3_f32 v9, v9, v76, v78
    s_waitcnt lgkmcnt(0)
    v_add_f32 v60, v60, v62
    v_add_f32 v61, v61, v63
    v_add_f32 v60, v60, v64
    v_add_f32 v61, v61, v65
    v_add_f32 v60, v60, v66
    v_add_f32 v61, v61, v67
    v_add_f32 v60, v60, v68
    v_add_f32 v61, v61, v69
    v_add_f32 v60, v60, v70
    v_add_f32 v61, v61, v71
    v_add_f32 v60, v60, v72
    v_add_f32 v61, v61, v73
    v_add_f32 v60, v60, v74
    v_add_f32 v61, v61, v75
    v_mul_f32 v60, v60, v78
    v_mul_f32 v61, v61, v78
    v_cvt_pk_bf16_f32 v60, v60, v61
    ds_write_b32 v7, v60 offset:9216
    ds_read_b128 v[52:55], v3 offset:15360
    s_waitcnt vmcnt(16)
    v_smfmac_f32_16x16x64_bf16 v[48:51], v[56:59], v[148:155], v2
    ds_read_b128 v[56:59], v3 offset:48128
    v_smfmac_f32_16x16x64_bf16 v[156:159], v[160:163], v[148:155], v2
    buffer_load_dwordx4 v[148:151], v4, s[36:39], s59 offen offset:2048 sc1
    buffer_load_dwordx4 v[152:155], v4, s[36:39], s59 offen offset:3072 sc1
    ds_read_b128 v[160:163], v3 offset:16384
    s_waitcnt lgkmcnt(2) vmcnt(16)
    v_smfmac_f32_16x16x64_bf16 v[48:51], v[52:55], v[116:123], v2
    ds_read_b128 v[52:55], v3 offset:49152
    s_waitcnt lgkmcnt(2)
    v_smfmac_f32_16x16x64_bf16 v[156:159], v[56:59], v[116:123], v2
    s_add_u32 s59, s10, 1581056
    buffer_load_dwordx4 v[116:119], v4, s[36:39], s59 offen offset:0 sc1
    buffer_load_dwordx4 v[120:123], v4, s[36:39], s59 offen offset:1024 sc1
    ds_read_b128 v[56:59], v3 offset:17408
    s_waitcnt vmcnt(16) lgkmcnt(2)
    v_smfmac_f32_16x16x64_bf16 v[48:51], v[160:163], v[124:131], v2
    ds_read_b128 v[160:163], v3 offset:50176
    s_waitcnt lgkmcnt(2)
    v_smfmac_f32_16x16x64_bf16 v[156:159], v[52:55], v[124:131], v2
    buffer_load_dwordx4 v[124:127], v4, s[36:39], s59 offen offset:2048 sc1
    buffer_load_dwordx4 v[128:131], v4, s[36:39], s59 offen offset:3072 sc1
    ds_read_b128 v[52:55], v3 offset:18432
    s_waitcnt lgkmcnt(2) vmcnt(16)
    v_smfmac_f32_16x16x64_bf16 v[48:51], v[56:59], v[84:91], v2
    ds_read_b128 v[56:59], v3 offset:51200
    s_waitcnt lgkmcnt(2)
    v_smfmac_f32_16x16x64_bf16 v[156:159], v[160:163], v[84:91], v2
    s_add_u32 s59, s10, 1585152
    buffer_load_dwordx4 v[84:87], v4, s[36:39], s59 offen offset:0 sc1
    buffer_load_dwordx4 v[88:91], v4, s[36:39], s59 offen offset:1024 sc1
    ds_read_b128 v[160:163], v3 offset:19456
    s_waitcnt lgkmcnt(2) vmcnt(16)
    v_smfmac_f32_16x16x64_bf16 v[48:51], v[52:55], v[92:99], v2
    ds_read_b128 v[52:55], v3 offset:52224
    s_waitcnt lgkmcnt(2)
    v_smfmac_f32_16x16x64_bf16 v[156:159], v[56:59], v[92:99], v2
    buffer_load_dwordx4 v[92:95], v4, s[36:39], s59 offen offset:2048 sc1
    buffer_load_dwordx4 v[96:99], v4, s[36:39], s59 offen offset:3072 sc1
    s_waitcnt vmcnt(16) lgkmcnt(1)
    v_smfmac_f32_16x16x64_bf16 v[48:51], v[160:163], v[132:139], v2
    s_waitcnt lgkmcnt(0)
    v_smfmac_f32_16x16x64_bf16 v[156:159], v[52:55], v[132:139], v2
    s_add_u32 s59, s11, 1572864
    buffer_load_dwordx4 v[132:135], v4, s[36:39], s59 offen offset:0 sc1
    buffer_load_dwordx4 v[136:139], v4, s[36:39], s59 offen offset:1024 sc1
    s_nop 0
    v_add_f32 v12, v48, v49
    v_add_f32 v13, v50, v51
    v_cvt_pk_bf16_f32 v12, v12, v13
    ds_write_b16 v1, v12 offset:5120
    ds_write_b16_d16_hi v1, v12 offset:5136
    v_add_f32 v12, v156, v157
    v_add_f32 v13, v158, v159
    v_cvt_pk_bf16_f32 v12, v12, v13
    ds_write_b16 v1, v12 offset:11264
    ds_write_b16_d16_hi v1, v12 offset:11280
    s_mov_b64 exec, 0xffff
    ds_read_b128 v[156:159], v166 offset:11264
    s_waitcnt lgkmcnt(0)
    buffer_store_dwordx4 v[156:159], v4, s[36:39], s68 offen offset:512 sc1
    s_mov_b64 exec, -1
    s_waitcnt lgkmcnt(0)
    s_barrier
    ds_read2st64_b32 v[52:53], v167 offset0:36 offset1:37
    ds_read2st64_b32 v[54:55], v167 offset0:38 offset1:39
    s_waitcnt vmcnt(17) lgkmcnt(0)
    v_smfmac_f32_16x16x64_bf16 v[16:19], v[52:55], v[100:107], v2
    buffer_load_dwordx4 v[100:103], v4, s[36:39], s59 offen offset:2048 sc1
    buffer_load_dwordx4 v[104:107], v4, s[36:39], s59 offen offset:3072 sc1
    s_waitcnt vmcnt(17)
    v_smfmac_f32_16x16x64_bf16 v[20:23], v[52:55], v[108:115], v2
    s_add_u32 s59, s11, 1576960
    buffer_load_dwordx4 v[108:111], v4, s[36:39], s59 offen offset:0 sc1
    buffer_load_dwordx4 v[112:115], v4, s[36:39], s59 offen offset:1024 sc1
    s_waitcnt vmcnt(17)
    v_smfmac_f32_16x16x64_bf16 v[24:27], v[52:55], v[140:147], v2
    buffer_load_dwordx4 v[140:143], v4, s[36:39], s59 offen offset:2048 sc1
    buffer_load_dwordx4 v[144:147], v4, s[36:39], s59 offen offset:3072 sc1
    s_waitcnt vmcnt(17)
    v_smfmac_f32_16x16x64_bf16 v[28:31], v[52:55], v[148:155], v2
    s_add_u32 s59, s11, 1581056
    buffer_load_dwordx4 v[148:151], v4, s[36:39], s59 offen offset:0 sc1
    buffer_load_dwordx4 v[152:155], v4, s[36:39], s59 offen offset:1024 sc1
    s_waitcnt vmcnt(17)
    v_smfmac_f32_16x16x64_bf16 v[32:35], v[52:55], v[116:123], v2
    buffer_load_dwordx4 v[116:119], v4, s[36:39], s59 offen offset:2048 sc1
    buffer_load_dwordx4 v[120:123], v4, s[36:39], s59 offen offset:3072 sc1
    s_waitcnt vmcnt(17)
    v_smfmac_f32_16x16x64_bf16 v[36:39], v[52:55], v[124:131], v2
    s_add_u32 s59, s11, 1585152
    buffer_load_dwordx4 v[124:127], v4, s[36:39], s59 offen offset:0 sc1
    buffer_load_dwordx4 v[128:131], v4, s[36:39], s59 offen offset:1024 sc1
    s_waitcnt vmcnt(17)
    v_smfmac_f32_16x16x64_bf16 v[40:43], v[52:55], v[84:91], v2
    buffer_load_dwordx4 v[84:87], v4, s[36:39], s59 offen offset:2048 sc1
    buffer_load_dwordx4 v[88:91], v4, s[36:39], s59 offen offset:3072 sc1
    s_waitcnt vmcnt(17)
    v_smfmac_f32_16x16x64_bf16 v[44:47], v[52:55], v[92:99], v2
    s_add_u32 s59, s14, 1048576
    buffer_load_dwordx4 v[92:95], v4, s[36:39], s59 offen offset:0 sc1
    buffer_load_dwordx4 v[96:99], v4, s[36:39], s59 offen offset:1024 sc1
    s_waitcnt lgkmcnt(0)
    s_barrier
    s_mov_b64 exec, 0xffff
    buffer_load_dwordx4 v[156:159], v4, s[36:39], s69 offen offset:512 sc1
    s_mov_b64 exec, -1
    ds_read_b128 v[76:79], v4 offset:10240
    ds_read_b64 v[60:61], v5 offset:0
    ds_read_b64 v[62:63], v5 offset:2048
    ds_read_b64 v[64:65], v5 offset:4096
    ds_read_b64 v[66:67], v5 offset:6144
    ds_read_b64 v[68:69], v5 offset:8192
    ds_read_b64 v[70:71], v5 offset:10240
    ds_read_b64 v[72:73], v5 offset:12288
    ds_read_b64 v[74:75], v5 offset:14336
    s_waitcnt lgkmcnt(8)
    v_add_f32 v76, v76, v77
    v_add_f32 v78, v78, v79
    v_add_f32 v77, v76, v78
    v_add_f32 v76, v76, v78
    s_nop 1
    v_permlane32_swap_b32 v76, v77
    v_add_f32 v76, v76, v77
    v_rcp_f32 v78, v76
    s_nop 0
    v_max3_f32 v9, v9, v76, v78
    s_waitcnt lgkmcnt(0)
    v_add_f32 v60, v60, v62
    v_add_f32 v61, v61, v63
    v_add_f32 v60, v60, v64
    v_add_f32 v61, v61, v65
    v_add_f32 v60, v60, v66
    v_add_f32 v61, v61, v67
    v_add_f32 v60, v60, v68
    v_add_f32 v61, v61, v69
    v_add_f32 v60, v60, v70
    v_add_f32 v61, v61, v71
    v_add_f32 v60, v60, v72
    v_add_f32 v61, v61, v73
    v_add_f32 v60, v60, v74
    v_add_f32 v61, v61, v75
    v_mul_f32 v60, v60, v78
    v_mul_f32 v61, v61, v78
    v_cvt_pk_bf16_f32 v60, v60, v61
    ds_write_b32 v7, v60 offset:9216
    s_mov_b64 exec, 0xffff
    s_waitcnt vmcnt(0)
    v_cmp_eq_u32 vcc, -1, v156
    s_cbranch_vccnz L_h_qx12
L_h_qb12:
    ds_write_b128 v166, v[156:159] offset:6144
    s_mov_b64 exec, -1
    s_waitcnt lgkmcnt(0)
    s_barrier
    ds_read2st64_b32 v[52:53], v167 offset0:36 offset1:37
    ds_read2st64_b32 v[54:55], v167 offset0:38 offset1:39
    s_waitcnt lgkmcnt(0)
    v_smfmac_f32_16x16x64_bf16 v[16:19], v[52:55], v[132:139], v2
    buffer_load_dwordx4 v[132:135], v4, s[36:39], s59 offen offset:2048 sc1
    buffer_load_dwordx4 v[136:139], v4, s[36:39], s59 offen offset:3072 sc1
    v_smfmac_f32_16x16x64_bf16 v[20:23], v[52:55], v[100:107], v2
    s_add_u32 s59, s14, 1052672
    buffer_load_dwordx4 v[100:103], v4, s[36:39], s59 offen offset:0 sc1
    buffer_load_dwordx4 v[104:107], v4, s[36:39], s59 offen offset:1024 sc1
    v_smfmac_f32_16x16x64_bf16 v[24:27], v[52:55], v[108:115], v2
    buffer_load_dwordx4 v[108:111], v4, s[36:39], s59 offen offset:2048 sc1
    buffer_load_dwordx4 v[112:115], v4, s[36:39], s59 offen offset:3072 sc1
    v_smfmac_f32_16x16x64_bf16 v[28:31], v[52:55], v[140:147], v2
    s_add_u32 s59, s14, 1056768
    buffer_load_dwordx4 v[140:143], v4, s[36:39], s59 offen offset:0 sc1
    buffer_load_dwordx4 v[144:147], v4, s[36:39], s59 offen offset:1024 sc1
    v_smfmac_f32_16x16x64_bf16 v[32:35], v[52:55], v[148:155], v2
    buffer_load_dwordx4 v[148:151], v4, s[36:39], s59 offen offset:2048 sc1
    buffer_load_dwordx4 v[152:155], v4, s[36:39], s59 offen offset:3072 sc1
    v_smfmac_f32_16x16x64_bf16 v[36:39], v[52:55], v[116:123], v2
    s_add_u32 s59, s14, 1060864
    buffer_load_dwordx4 v[116:119], v4, s[36:39], s59 offen offset:0 sc1
    buffer_load_dwordx4 v[120:123], v4, s[36:39], s59 offen offset:1024 sc1
    v_smfmac_f32_16x16x64_bf16 v[40:43], v[52:55], v[124:131], v2
    buffer_load_dwordx4 v[124:127], v4, s[36:39], s59 offen offset:2048 sc1
    buffer_load_dwordx4 v[128:131], v4, s[36:39], s59 offen offset:3072 sc1
    v_smfmac_f32_16x16x64_bf16 v[44:47], v[52:55], v[84:91], v2
    s_add_u32 s59, s12, 1572864
    buffer_load_dwordx4 v[84:87], v4, s[36:39], s59 offen offset:0 sc1
    buffer_load_dwordx4 v[88:91], v4, s[36:39], s59 offen offset:1024 sc1
    ds_read_b128 v[48:51], v15
    ds_read_b128 v[156:159], v15
    ds_read_b128 v[52:55], v3 offset:12288
    ds_read_b128 v[56:59], v3 offset:45056
    ds_read_b128 v[160:163], v3 offset:13312
    s_waitcnt lgkmcnt(2)
    v_smfmac_f32_16x16x64_bf16 v[48:51], v[52:55], v[92:99], v2
    ds_read_b128 v[52:55], v3 offset:46080
    s_waitcnt lgkmcnt(2)
    v_smfmac_f32_16x16x64_bf16 v[156:159], v[56:59], v[92:99], v2
    buffer_load_dwordx4 v[92:95], v4, s[36:39], s59 offen offset:2048 sc1
    buffer_load_dwordx4 v[96:99], v4, s[36:39], s59 offen offset:3072 sc1
    ds_read_b128 v[56:59], v3 offset:14336
    s_waitcnt vmcnt(16) lgkmcnt(2)
    v_smfmac_f32_16x16x64_bf16 v[48:51], v[160:163], v[132:139], v2
    ds_read_b128 v[160:163], v3 offset:47104
    s_waitcnt lgkmcnt(2)
    v_smfmac_f32_16x16x64_bf16 v[156:159], v[52:55], v[132:139], v2
    s_add_u32 s59, s12, 1576960
    buffer_load_dwordx4 v[132:135], v4, s[36:39], s59 offen offset:0 sc1
    buffer_load_dwordx4 v[136:139], v4, s[36:39], s59 offen offset:1024 sc1
    s_waitcnt lgkmcnt(0)
    s_barrier
    ds_read_b128 v[76:79], v4 offset:10240
    ds_read_b64 v[60:61], v5 offset:0
    ds_read_b64 v[62:63], v5 offset:2048
    ds_read_b64 v[64:65], v5 offset:4096
    ds_read_b64 v[66:67], v5 offset:6144
    ds_read_b64 v[68:69], v5 offset:8192
    ds_read_b64 v[70:71], v5 offset:10240
    ds_read_b64 v[72:73], v5 offset:12288
    ds_read_b64 v[74:75], v5 offset:14336
    s_waitcnt lgkmcnt(8)
    v_add_f32 v76, v76, v77
    v_add_f32 v78, v78, v79
    v_add_f32 v77, v76, v78
    v_add_f32 v76, v76, v78
    s_nop 1
    v_permlane32_swap_b32 v76, v77
    v_add_f32 v76, v76, v77
    v_rcp_f32 v78, v76
    s_nop 0
    v_max3_f32 v9, v9, v76, v78
    s_waitcnt lgkmcnt(0)
    v_add_f32 v60, v60, v62
    v_add_f32 v61, v61, v63
    v_add_f32 v60, v60, v64
    v_add_f32 v61, v61, v65
    v_add_f32 v60, v60, v66
    v_add_f32 v61, v61, v67
    v_add_f32 v60, v60, v68
    v_add_f32 v61, v61, v69
    v_add_f32 v60, v60, v70
    v_add_f32 v61, v61, v71
    v_add_f32 v60, v60, v72
    v_add_f32 v61, v61, v73
    v_add_f32 v60, v60, v74
    v_add_f32 v61, v61, v75
    v_mul_f32 v60, v60, v78
    v_mul_f32 v61, v61, v78
    v_cvt_pk_bf16_f32 v60, v60, v61
    ds_write_b32 v7, v60 offset:9216
    ds_read_b128 v[52:55], v3 offset:15360
    s_waitcnt vmcnt(16)
    v_smfmac_f32_16x16x64_bf16 v[48:51], v[56:59], v[100:107], v2
    ds_read_b128 v[56:59], v3 offset:48128
    v_smfmac_f32_16x16x64_bf16 v[156:159], v[160:163], v[100:107], v2
    buffer_load_dwordx4 v[100:103], v4, s[36:39], s59 offen offset:2048 sc1
    buffer_load_dwordx4 v[104:107], v4, s[36:39], s59 offen offset:3072 sc1
    ds_read_b128 v[160:163], v3 offset:16384
    s_waitcnt vmcnt(16) lgkmcnt(2)
    v_smfmac_f32_16x16x64_bf16 v[48:51], v[52:55], v[108:115], v2
    ds_read_b128 v[52:55], v3 offset:49152
    s_waitcnt lgkmcnt(2)
    v_smfmac_f32_16x16x64_bf16 v[156:159], v[56:59], v[108:115], v2
    s_add_u32 s59, s12, 1581056
    buffer_load_dwordx4 v[108:111], v4, s[36:39], s59 offen offset:0 sc1
    buffer_load_dwordx4 v[112:115], v4, s[36:39], s59 offen offset:1024 sc1
    ds_read_b128 v[56:59], v3 offset:17408
    s_waitcnt vmcnt(16) lgkmcnt(2)
    v_smfmac_f32_16x16x64_bf16 v[48:51], v[160:163], v[140:147], v2
    ds_read_b128 v[160:163], v3 offset:50176
    s_waitcnt lgkmcnt(2)
    v_smfmac_f32_16x16x64_bf16 v[156:159], v[52:55], v[140:147], v2
    buffer_load_dwordx4 v[140:143], v4, s[36:39], s59 offen offset:2048 sc1
    buffer_load_dwordx4 v[144:147], v4, s[36:39], s59 offen offset:3072 sc1
    ds_read_b128 v[52:55], v3 offset:18432
    s_waitcnt lgkmcnt(2) vmcnt(16)
    v_smfmac_f32_16x16x64_bf16 v[48:51], v[56:59], v[148:155], v2
    ds_read_b128 v[56:59], v3 offset:51200
    s_waitcnt lgkmcnt(2)
    v_smfmac_f32_16x16x64_bf16 v[156:159], v[160:163], v[148:155], v2
    s_add_u32 s59, s12, 1585152
    buffer_load_dwordx4 v[148:151], v4, s[36:39], s59 offen offset:0 sc1
    buffer_load_dwordx4 v[152:155], v4, s[36:39], s59 offen offset:1024 sc1
    ds_read_b128 v[160:163], v3 offset:19456
    s_waitcnt lgkmcnt(2) vmcnt(16)
    v_smfmac_f32_16x16x64_bf16 v[48:51], v[52:55], v[116:123], v2
    ds_read_b128 v[52:55], v3 offset:52224
    s_waitcnt lgkmcnt(2)
    v_smfmac_f32_16x16x64_bf16 v[156:159], v[56:59], v[116:123], v2
    buffer_load_dwordx4 v[116:119], v4, s[36:39], s59 offen offset:2048 sc1
    buffer_load_dwordx4 v[120:123], v4, s[36:39], s59 offen offset:3072 sc1
    s_waitcnt vmcnt(16) lgkmcnt(1)
    v_smfmac_f32_16x16x64_bf16 v[48:51], v[160:163], v[124:131], v2
    s_waitcnt lgkmcnt(0)
    v_smfmac_f32_16x16x64_bf16 v[156:159], v[52:55], v[124:131], v2
    s_add_u32 s59, s13, 1572864
    buffer_load_dwordx4 v[124:127], v4, s[36:39], s59 offen offset:0 sc1
    buffer_load_dwordx4 v[128:131], v4, s[36:39], s59 offen offset:1024 sc1
    s_nop 0
    v_add_f32 v12, v48, v49
    v_add_f32 v13, v50, v51
    v_cvt_pk_bf16_f32 v12, v12, v13
    ds_write_b16 v1, v12 offset:7168
    ds_write_b16_d16_hi v1, v12 offset:7184
    v_add_f32 v12, v156, v157
    v_add_f32 v13, v158, v159
    v_cvt_pk_bf16_f32 v12, v12, v13
    ds_write_b16 v1, v12 offset:11264
    ds_write_b16_d16_hi v1, v12 offset:11280
    s_mov_b64 exec, 0xffff
    ds_read_b128 v[156:159], v166 offset:11264
    s_waitcnt lgkmcnt(0)
    buffer_store_dwordx4 v[156:159], v4, s[36:39], s68 offen offset:768 sc1
    s_mov_b64 exec, -1
    s_waitcnt lgkmcnt(0)
    s_barrier
    ds_read2st64_b32 v[52:53], v167 offset0:36 offset1:37
    ds_read2st64_b32 v[54:55], v167 offset0:38 offset1:39
    s_waitcnt vmcnt(17) lgkmcnt(0)
    v_smfmac_f32_16x16x64_bf16 v[16:19], v[52:55], v[84:91], v2
    buffer_load_dwordx4 v[84:87], v4, s[36:39], s59 offen offset:2048 sc1
    buffer_load_dwordx4 v[88:91], v4, s[36:39], s59 offen offset:3072 sc1
    s_waitcnt vmcnt(17)
    v_smfmac_f32_16x16x64_bf16 v[20:23], v[52:55], v[92:99], v2
    s_add_u32 s59, s13, 1576960
    buffer_load_dwordx4 v[92:95], v4, s[36:39], s59 offen offset:0 sc1
    buffer_load_dwordx4 v[96:99], v4, s[36:39], s59 offen offset:1024 sc1
    s_waitcnt vmcnt(17)
    v_smfmac_f32_16x16x64_bf16 v[24:27], v[52:55], v[132:139], v2
    buffer_load_dwordx4 v[132:135], v4, s[36:39], s59 offen offset:2048 sc1
    buffer_load_dwordx4 v[136:139], v4, s[36:39], s59 offen offset:3072 sc1
    s_waitcnt vmcnt(17)
    v_smfmac_f32_16x16x64_bf16 v[28:31], v[52:55], v[100:107], v2
    s_add_u32 s59, s13, 1581056
    buffer_load_dwordx4 v[100:103], v4, s[36:39], s59 offen offset:0 sc1
    buffer_load_dwordx4 v[104:107], v4, s[36:39], s59 offen offset:1024 sc1
    s_waitcnt vmcnt(17)
    v_smfmac_f32_16x16x64_bf16 v[32:35], v[52:55], v[108:115], v2
    buffer_load_dwordx4 v[108:111], v4, s[36:39], s59 offen offset:2048 sc1
    buffer_load_dwordx4 v[112:115], v4, s[36:39], s59 offen offset:3072 sc1
    s_waitcnt vmcnt(17)
    v_smfmac_f32_16x16x64_bf16 v[36:39], v[52:55], v[140:147], v2
    s_add_u32 s59, s13, 1585152
    buffer_load_dwordx4 v[140:143], v4, s[36:39], s59 offen offset:0 sc1
    buffer_load_dwordx4 v[144:147], v4, s[36:39], s59 offen offset:1024 sc1
    s_waitcnt vmcnt(17)
    v_smfmac_f32_16x16x64_bf16 v[40:43], v[52:55], v[148:155], v2
    buffer_load_dwordx4 v[148:151], v4, s[36:39], s59 offen offset:2048 sc1
    buffer_load_dwordx4 v[152:155], v4, s[36:39], s59 offen offset:3072 sc1
    s_waitcnt vmcnt(17)
    v_smfmac_f32_16x16x64_bf16 v[44:47], v[52:55], v[116:123], v2
    s_add_u32 s59, s14, 1572864
    buffer_load_dwordx4 v[116:119], v4, s[36:39], s59 offen offset:0 sc1
    buffer_load_dwordx4 v[120:123], v4, s[36:39], s59 offen offset:1024 sc1
    s_waitcnt lgkmcnt(0)
    s_barrier
    s_mov_b64 exec, 0xffff
    buffer_load_dwordx4 v[156:159], v4, s[36:39], s69 offen offset:768 sc1
    s_mov_b64 exec, -1
    ds_read_b128 v[76:79], v4 offset:10240
    ds_read_b64 v[60:61], v5 offset:0
    ds_read_b64 v[62:63], v5 offset:2048
    ds_read_b64 v[64:65], v5 offset:4096
    ds_read_b64 v[66:67], v5 offset:6144
    ds_read_b64 v[68:69], v5 offset:8192
    ds_read_b64 v[70:71], v5 offset:10240
    ds_read_b64 v[72:73], v5 offset:12288
    ds_read_b64 v[74:75], v5 offset:14336
    s_waitcnt lgkmcnt(8)
    v_add_f32 v76, v76, v77
    v_add_f32 v78, v78, v79
    v_add_f32 v77, v76, v78
    v_add_f32 v76, v76, v78
    s_nop 1
    v_permlane32_swap_b32 v76, v77
    v_add_f32 v76, v76, v77
    v_rcp_f32 v78, v76
    s_nop 0
    v_max3_f32 v9, v9, v76, v78
    s_waitcnt lgkmcnt(0)
    v_add_f32 v60, v60, v62
    v_add_f32 v61, v61, v63
    v_add_f32 v60, v60, v64
    v_add_f32 v61, v61, v65
    v_add_f32 v60, v60, v66
    v_add_f32 v61, v61, v67
    v_add_f32 v60, v60, v68
    v_add_f32 v61, v61, v69
    v_add_f32 v60, v60, v70
    v_add_f32 v61, v61, v71
    v_add_f32 v60, v60, v72
    v_add_f32 v61, v61, v73
    v_add_f32 v60, v60, v74
    v_add_f32 v61, v61, v75
    v_mul_f32 v60, v60, v78
    v_mul_f32 v61, v61, v78
    v_cvt_pk_bf16_f32 v60, v60, v61
    ds_write_b32 v7, v60 offset:9216
    s_mov_b64 exec, 0xffff
    s_waitcnt vmcnt(0)
    v_cmp_eq_u32 vcc, -1, v156
    s_cbranch_vccnz L_h_qx13
L_h_qb13:
    ds_write_b128 v166, v[156:159] offset:8192
    s_mov_b64 exec, -1
    s_waitcnt lgkmcnt(0)
    buffer_load_dwordx4 v[156:159], v4, s[36:39], s59 offen offset:2048 sc1
    buffer_load_dwordx4 v[160:163], v4, s[36:39], s59 offen offset:3072 sc1
    s_waitcnt lgkmcnt(0)
    s_barrier
    ds_read2st64_b32 v[52:53], v167 offset0:36 offset1:37
    ds_read2st64_b32 v[54:55], v167 offset0:38 offset1:39
    s_waitcnt lgkmcnt(0)
    v_smfmac_f32_16x16x64_bf16 v[16:19], v[52:55], v[124:131], v2
    s_add_u32 s59, s14, 1576960
    buffer_load_dwordx4 v[124:127], v4, s[36:39], s59 offen offset:0 sc1
    buffer_load_dwordx4 v[128:131], v4, s[36:39], s59 offen offset:1024 sc1
    v_smfmac_f32_16x16x64_bf16 v[20:23], v[52:55], v[84:91], v2
    buffer_load_dwordx4 v[84:87], v4, s[36:39], s59 offen offset:2048 sc1
    buffer_load_dwordx4 v[88:91], v4, s[36:39], s59 offen offset:3072 sc1
    v_smfmac_f32_16x16x64_bf16 v[24:27], v[52:55], v[92:99], v2
    s_add_u32 s59, s14, 1581056
    buffer_load_dwordx4 v[92:95], v4, s[36:39], s59 offen offset:0 sc1
    buffer_load_dwordx4 v[96:99], v4, s[36:39], s59 offen offset:1024 sc1
    v_smfmac_f32_16x16x64_bf16 v[28:31], v[52:55], v[132:139], v2
    buffer_load_dwordx4 v[132:135], v4, s[36:39], s59 offen offset:2048 sc1
    buffer_load_dwordx4 v[136:139], v4, s[36:39], s59 offen offset:3072 sc1
    v_smfmac_f32_16x16x64_bf16 v[32:35], v[52:55], v[100:107], v2
    s_add_u32 s59, s14, 1585152
    buffer_load_dwordx4 v[100:103], v4, s[36:39], s59 offen offset:0 sc1
    buffer_load_dwordx4 v[104:107], v4, s[36:39], s59 offen offset:1024 sc1
    v_smfmac_f32_16x16x64_bf16 v[36:39], v[52:55], v[108:115], v2
    buffer_load_dwordx4 v[108:111], v4, s[36:39], s59 offen offset:2048 sc1
    buffer_load_dwordx4 v[112:115], v4, s[36:39], s59 offen offset:3072 sc1
    v_smfmac_f32_16x16x64_bf16 v[40:43], v[52:55], v[140:147], v2
    s_add_u32 s59, s15, 1572864
    buffer_load_dwordx4 v[140:143], v4, s[36:39], s59 offen offset:0 sc1
    buffer_load_dwordx4 v[144:147], v4, s[36:39], s59 offen offset:1024 sc1
    v_smfmac_f32_16x16x64_bf16 v[44:47], v[52:55], v[148:155], v2
    buffer_load_dwordx4 v[148:151], v4, s[36:39], s59 offen offset:2048 sc1
    buffer_load_dwordx4 v[152:155], v4, s[36:39], s59 offen offset:3072 sc1
    s_waitcnt lgkmcnt(0)
    s_barrier
    ds_read_b128 v[76:79], v4 offset:10240
    ds_read_b64 v[60:61], v5 offset:0
    ds_read_b64 v[62:63], v5 offset:2048
    ds_read_b64 v[64:65], v5 offset:4096
    ds_read_b64 v[66:67], v5 offset:6144
    ds_read_b64 v[68:69], v5 offset:8192
    ds_read_b64 v[70:71], v5 offset:10240
    ds_read_b64 v[72:73], v5 offset:12288
    ds_read_b64 v[74:75], v5 offset:14336
    s_waitcnt lgkmcnt(8)
    v_add_f32 v76, v76, v77
    v_add_f32 v78, v78, v79
    v_add_f32 v77, v76, v78
    v_add_f32 v76, v76, v78
    s_nop 1
    v_permlane32_swap_b32 v76, v77
    v_add_f32 v76, v76, v77
    v_rcp_f32 v78, v76
    s_nop 0
    v_max3_f32 v9, v9, v76, v78
    s_waitcnt lgkmcnt(0)
    v_add_f32 v60, v60, v62
    v_add_f32 v61, v61, v63
    v_add_f32 v60, v60, v64
    v_add_f32 v61, v61, v65
    v_add_f32 v60, v60, v66
    v_add_f32 v61, v61, v67
    v_add_f32 v60, v60, v68
    v_add_f32 v61, v61, v69
    v_add_f32 v60, v60, v70
    v_add_f32 v61, v61, v71
    v_add_f32 v60, v60, v72
    v_add_f32 v61, v61, v73
    v_add_f32 v60, v60, v74
    v_add_f32 v61, v61, v75
    v_mul_f32 v60, v60, v78
    v_mul_f32 v61, v61, v78
    v_cvt_pk_bf16_f32 v60, v60, v61
    ds_write_b32 v7, v60 offset:9216
    s_waitcnt lgkmcnt(0)
    s_barrier
    ds_read2st64_b32 v[52:53], v167 offset0:36 offset1:37
    ds_read2st64_b32 v[54:55], v167 offset0:38 offset1:39
    s_waitcnt lgkmcnt(0)
    v_smfmac_f32_16x16x64_bf16 v[16:19], v[52:55], v[116:123], v2
    s_add_u32 s59, s15, 1576960
    buffer_load_dwordx4 v[116:119], v4, s[36:39], s59 offen offset:0 sc1
    buffer_load_dwordx4 v[120:123], v4, s[36:39], s59 offen offset:1024 sc1
    s_waitcnt vmcnt(18)
    v_smfmac_f32_16x16x64_bf16 v[20:23], v[52:55], v[156:163], v2
    buffer_load_dwordx4 v[156:159], v4, s[36:39], s59 offen offset:2048 sc1
    buffer_load_dwordx4 v[160:163], v4, s[36:39], s59 offen offset:3072 sc1
    s_waitcnt vmcnt(18)
    v_smfmac_f32_16x16x64_bf16 v[24:27], v[52:55], v[124:131], v2
    s_add_u32 s59, s15, 1581056
    buffer_load_dwordx4 v[124:127], v4, s[36:39], s59 offen offset:0 sc1
    buffer_load_dwordx4 v[128:131], v4, s[36:39], s59 offen offset:1024 sc1
    s_waitcnt vmcnt(18)
    v_smfmac_f32_16x16x64_bf16 v[28:31], v[52:55], v[84:91], v2
    buffer_load_dwordx4 v[84:87], v4, s[36:39], s59 offen offset:2048 sc1
    buffer_load_dwordx4 v[88:91], v4, s[36:39], s59 offen offset:3072 sc1
    s_waitcnt vmcnt(18)
    v_smfmac_f32_16x16x64_bf16 v[32:35], v[52:55], v[92:99], v2
    s_add_u32 s59, s15, 1585152
    buffer_load_dwordx4 v[92:95], v4, s[36:39], s59 offen offset:0 sc1
    buffer_load_dwordx4 v[96:99], v4, s[36:39], s59 offen offset:1024 sc1
    s_waitcnt vmcnt(18)
    v_smfmac_f32_16x16x64_bf16 v[36:39], v[52:55], v[132:139], v2
    buffer_load_dwordx4 v[132:135], v4, s[36:39], s59 offen offset:2048 sc1
    buffer_load_dwordx4 v[136:139], v4, s[36:39], s59 offen offset:3072 sc1
    s_waitcnt vmcnt(18)
    v_smfmac_f32_16x16x64_bf16 v[40:43], v[52:55], v[100:107], v2
    s_waitcnt vmcnt(16)
    v_smfmac_f32_16x16x64_bf16 v[44:47], v[52:55], v[108:115], v2
    v_lshrrev_b32 v12, 4, v0
    v_and_b32 v13, 15, v0
    v_lshlrev_b32 v13, 3, v13
    v_lshl_add_u32 v12, v12, 12, v13
    s_lshl_b32 s6, s56, 7
    s_add_u32 s6, s6, 28672
    v_add_u32 v12, s6, v12
    s_waitcnt lgkmcnt(0)
    s_barrier
    s_setprio 3
    ds_read_b128 v[76:79], v6 offset:10240
    ds_read_b128 v[80:83], v6 offset:10752
    ds_read_b64 v[60:61], v5 offset:0
    ds_read_b64 v[62:63], v5 offset:2048
    ds_read_b64 v[64:65], v5 offset:4096
    ds_read_b64 v[66:67], v5 offset:6144
    ds_read_b64 v[68:69], v5 offset:8192
    ds_read_b64 v[70:71], v5 offset:10240
    ds_read_b64 v[72:73], v5 offset:12288
    ds_read_b64 v[74:75], v5 offset:14336
    s_waitcnt lgkmcnt(8)
    v_pk_add_f32 v[80:81], v[80:81], v[82:83]
    v_pk_add_f32 v[76:77], v[76:77], v[78:79]
    v_pk_add_f32 v[76:77], v[76:77], v[80:81]
    v_add_f32 v76, v76, v77
    v_rcp_f32 v78, v76
    s_nop 0
    v_max3_f32 v9, v9, v76, v78
    v_cmp_ngt_f32 vcc, 1400897536, v9
    s_nop 0
    s_or_b32 s84, vcc_lo, vcc_hi
    v_mov_b32 v13, s84
    ds_write_b32 v15, v13 offset:80
    s_waitcnt lgkmcnt(5)
    v_pk_add_f32 v[64:65], v[64:65], v[66:67]
    v_pk_add_f32 v[60:61], v[60:61], v[62:63]
    v_pk_add_f32 v[60:61], v[60:61], v[64:65]
    s_waitcnt lgkmcnt(1)
    v_pk_add_f32 v[72:73], v[72:73], v[74:75]
    v_pk_add_f32 v[68:69], v[68:69], v[70:71]
    v_pk_add_f32 v[60:61], v[60:61], v[72:73]
    v_pk_add_f32 v[60:61], v[60:61], v[68:69]
    v_pk_mul_f32 v[60:61], v[60:61], v[78:79] op_sel_hi:[1,0]
    v_cvt_pk_bf16_f32 v60, v60, v61
    ds_write_b32 v7, v60 offset:9216
    s_waitcnt vmcnt(0)
    s_waitcnt lgkmcnt(0)
    s_barrier
    s_cmp_lg_u32 s84, 0
    s_cbranch_scc1 L_h_exact1
L_h_rejoin1:
    ds_read2st64_b32 v[52:53], v167 offset0:36 offset1:37
    ds_read2st64_b32 v[54:55], v167 offset0:38 offset1:39
    s_waitcnt lgkmcnt(0)
    v_smfmac_f32_16x16x64_bf16 v[16:19], v[52:55], v[140:147], v2
    v_smfmac_f32_16x16x64_bf16 v[20:23], v[52:55], v[148:155], v2
    v_smfmac_f32_16x16x64_bf16 v[24:27], v[52:55], v[116:123], v2
    v_smfmac_f32_16x16x64_bf16 v[28:31], v[52:55], v[156:163], v2
    v_smfmac_f32_16x16x64_bf16 v[32:35], v[52:55], v[124:131], v2
    v_add_f32 v60, v16, v17
    v_add_f32 v68, v18, v19
    v_smfmac_f32_16x16x64_bf16 v[36:39], v[52:55], v[84:91], v2
    v_add_f32 v61, v20, v21
    v_add_f32 v69, v22, v23
    ds_write_b64 v12, v[60:61] offset:0
    ds_write_b64 v12, v[68:69] offset:2048
    v_smfmac_f32_16x16x64_bf16 v[40:43], v[52:55], v[92:99], v2
    v_add_f32 v62, v24, v25
    v_add_f32 v70, v26, v27
    v_smfmac_f32_16x16x64_bf16 v[44:47], v[52:55], v[132:139], v2
    v_add_f32 v63, v28, v29
    v_add_f32 v71, v30, v31
    ds_write_b64 v12, v[62:63] offset:512
    ds_write_b64 v12, v[70:71] offset:2560
    v_add_f32 v64, v32, v33
    v_add_f32 v72, v34, v35
    v_add_f32 v65, v36, v37
    v_add_f32 v73, v38, v39
    ds_write_b64 v12, v[64:65] offset:1024
    ds_write_b64 v12, v[72:73] offset:3072
    v_add_f32 v66, v40, v41
    v_add_f32 v74, v42, v43
    v_add_f32 v67, v44, v45
    v_add_f32 v75, v46, v47
    ds_write_b64 v12, v[66:67] offset:1536
    ds_write_b64 v12, v[74:75] offset:3584
    s_waitcnt lgkmcnt(0)
    s_barrier
    s_setprio 2
    s_cmp_lg_u32 s56, 0
    s_cbranch_scc1 L_h_nohint1
    s_cmp_lg_u32 s4, 0
    s_cbranch_scc1 L_h_nohint1
    v_mov_b32 v12, s5
    s_mov_b64 exec, 1
    buffer_store_dword v12, v15, s[36:39], 0 offen
    s_mov_b64 exec, -1
L_h_nohint1:
    s_endpgm
L_h_qx00:
    s_mov_b32 s78, 20000
L_h_qa00:
    s_sub_u32 s78, s78, 1
    s_cmp_lt_i32 s78, 0
    s_cbranch_scc1 L_h_qb00
    s_sleep 6
    buffer_load_dwordx4 v[156:159], v4, s[36:39], s69 offen offset:0 sc1
    s_waitcnt vmcnt(0)
    v_cmp_eq_u32 vcc, -1, v156
    s_cbranch_vccnz L_h_qa00
    s_branch L_h_qb00
L_h_fw_slow:
    s_mov_b32 s78, 20000
L_h_fw:
    v_lshlrev_b32 v165, 5, v0
    buffer_load_dword v164, v165, s[36:39], s77 offen sc1
    buffer_load_dword v165, v165, s[36:39], s83 offen sc1
    s_waitcnt vmcnt(0)
    v_cmp_ne_u32 vcc, s5, v164
    v_cmp_ne_u32 s[6:7], s5, v165
    s_nop 0
    s_or_b64 vcc, vcc, s[6:7]
    s_cbranch_vccz L_h_fw_ok
    s_sleep 8
    s_sub_u32 s78, s78, 1
    s_cmp_lg_u32 s78, 0
    s_cbranch_scc1 L_h_fw
L_h_fw_ok:
    s_branch L_h_fw_back
L_h_fu_slow:
    s_mov_b32 s78, 20000
L_h_fu:
    v_lshlrev_b32 v164, 1, v6
    buffer_load_dword v164, v164, s[36:39], s79 offen sc1
    s_waitcnt vmcnt(0)
    v_cmp_ne_u32 vcc, s5, v164
    s_cbranch_vccz L_h_fu_ok
    s_sleep 8
    s_sub_u32 s78, s78, 1
    s_cmp_lg_u32 s78, 0
    s_cbranch_scc1 L_h_fu
L_h_fu_ok:
    s_branch L_h_fu_back
L_h_qx01:
    s_mov_b32 s78, 20000
L_h_qa01:
    s_sub_u32 s78, s78, 1
    s_cmp_lt_i32 s78, 0
    s_cbranch_scc1 L_h_qb01
    s_sleep 6
    buffer_load_dwordx4 v[156:159], v4, s[36:39], s69 offen offset:256 sc1
    s_waitcnt vmcnt(0)
    v_cmp_eq_u32 vcc, -1, v156
    s_cbranch_vccnz L_h_qa01
    s_branch L_h_qb01
L_h_qx02:
    s_mov_b32 s78, 20000
L_h_qa02:
    s_sub_u32 s78, s78, 1
    s_cmp_lt_i32 s78, 0
    s_cbranch_scc1 L_h_qb02
    s_sleep 6
    buffer_load_dwordx4 v[156:159], v4, s[36:39], s69 offen offset:512 sc1
    s_waitcnt vmcnt(0)
    v_cmp_eq_u32 vcc, -1, v156
    s_cbranch_vccnz L_h_qa02
    s_branch L_h_qb02
L_h_qx03:
    s_mov_b32 s78, 20000
L_h_qa03:
    s_sub_u32 s78, s78, 1
    s_cmp_lt_i32 s78, 0
    s_cbranch_scc1 L_h_qb03
    s_sleep 6
    buffer_load_dwordx4 v[156:159], v4, s[36:39], s69 offen offset:768 sc1
    s_waitcnt vmcnt(0)
    v_cmp_eq_u32 vcc, -1, v156
    s_cbranch_vccnz L_h_qa03
    s_branch L_h_qb03
L_h_fy_slow:
    s_mov_b32 s78, 20000
L_h_fy:
    v_lshlrev_b32 v165, 5, v0
    buffer_load_dword v164, v165, s[36:39], s79 offen sc1
    buffer_load_dword v165, v165, s[36:39], s79 offen offset:2048 sc1
    s_waitcnt vmcnt(0)
    v_cmp_ne_u32 vcc, s5, v164
    v_cmp_ne_u32 s[6:7], s5, v165
    s_nop 0
    s_or_b64 vcc, vcc, s[6:7]
    s_cbranch_vccz L_h_fy_ok
    s_sleep 8
    s_sub_u32 s78, s78, 1
    s_cmp_lg_u32 s78, 0
    s_cbranch_scc1 L_h_fy
L_h_fy_ok:
    s_branch L_h_fy_back
L_h_exact0:
    s_waitcnt vmcnt(0) lgkmcnt(0)
    v_mov_b64 v[16:17], 0
    v_mov_b64 v[18:19], 0
    v_mov_b64 v[20:21], 0
    v_mov_b64 v[22:23], 0
    v_mov_b64 v[24:25], 0
    v_mov_b64 v[26:27], 0
    v_mov_b64 v[28:29], 0
    v_mov_b64 v[30:31], 0
    v_mov_b64 v[32:33], 0
    v_mov_b64 v[34:35], 0
    v_mov_b64 v[36:37], 0
    v_mov_b64 v[38:39], 0
    v_mov_b64 v[40:41], 0
    v_mov_b64 v[42:43], 0
    v_mov_b64 v[44:45], 0
    v_mov_b64 v[46:47], 0
    s_mov_b32 s85, s8
    s_mov_b32 s86, 0
L_h_ex0:
    s_add_u32 s6, s85, 1572864
    buffer_load_dwordx4 v[132:135], v4, s[36:39], s6 offen sc1
    buffer_load_dwordx4 v[136:139], v4, s[36:39], s6 offen offset:1024 sc1
    s_add_u32 s6, s85, 1574912
    buffer_load_dwordx4 v[100:103], v4, s[36:39], s6 offen sc1
    buffer_load_dwordx4 v[104:107], v4, s[36:39], s6 offen offset:1024 sc1
    s_add_u32 s6, s85, 1576960
    buffer_load_dwordx4 v[108:111], v4, s[36:39], s6 offen sc1
    buffer_load_dwordx4 v[112:115], v4, s[36:39], s6 offen offset:1024 sc1
    s_add_u32 s6, s85, 1579008
    buffer_load_dwordx4 v[156:159], v4, s[36:39], s6 offen sc1
    buffer_load_dwordx4 v[160:163], v4, s[36:39], s6 offen offset:1024 sc1
    s_add_u32 s6, s85, 1581056
    buffer_load_dwordx4 v[140:143], v4, s[36:39], s6 offen sc1
    buffer_load_dwordx4 v[144:147], v4, s[36:39], s6 offen offset:1024 sc1
    s_add_u32 s6, s85, 1583104
    buffer_load_dwordx4 v[148:151], v4, s[36:39], s6 offen sc1
    buffer_load_dwordx4 v[152:155], v4, s[36:39], s6 offen offset:1024 sc1
    s_add_u32 s6, s85, 1585152
    buffer_load_dwordx4 v[116:119], v4, s[36:39], s6 offen sc1
    buffer_load_dwordx4 v[120:123], v4, s[36:39], s6 offen offset:1024 sc1
    s_add_u32 s6, s85, 1587200
    buffer_load_dwordx4 v[124:127], v4, s[36:39], s6 offen sc1
    buffer_load_dwordx4 v[128:131], v4, s[36:39], s6 offen offset:1024 sc1
    s_barrier
    s_barrier
    ds_read_b128 v[76:79], v4 offset:10240
    ds_read_b64 v[60:61], v5 offset:0
    ds_read_b64 v[62:63], v5 offset:2048
    ds_read_b64 v[64:65], v5 offset:4096
    ds_read_b64 v[66:67], v5 offset:6144
    ds_read_b64 v[68:69], v5 offset:8192
    ds_read_b64 v[70:71], v5 offset:10240
    ds_read_b64 v[72:73], v5 offset:12288
    ds_read_b64 v[74:75], v5 offset:14336
    s_waitcnt lgkmcnt(8)
    v_add_f32 v76, v76, v77
    v_add_f32 v78, v78, v79
    v_add_f32 v77, v76, v78
    v_add_f32 v76, v76, v78
    s_nop 1
    v_permlane32_swap_b32 v76, v77
    v_add_f32 v76, v76, v77
    v_rcp_f32 v78, v76
    s_nop 0
    v_max3_f32 v9, v9, v76, v78
    s_waitcnt lgkmcnt(0)
    v_add_f32 v60, v60, v62
    v_add_f32 v61, v61, v63
    v_add_f32 v60, v60, v64
    v_add_f32 v61, v61, v65
    v_add_f32 v60, v60, v66
    v_add_f32 v61, v61, v67
    v_add_f32 v60, v60, v68
    v_add_f32 v61, v61, v69
    v_add_f32 v60, v60, v70
    v_add_f32 v61, v61, v71
    v_add_f32 v60, v60, v72
    v_add_f32 v61, v61, v73
    v_add_f32 v60, v60, v74
    v_add_f32 v61, v61, v75
    v_mul_f32 v60, v60, v78
    v_mul_f32 v61, v61, v78
    v_cvt_pk_bf16_f32 v60, v60, v61
    ds_write_b32 v7, v60 offset:9216
    s_waitcnt vmcnt(0) lgkmcnt(0)
    s_barrier
    s_cmp_eq_u32 s86, 7
    s_cbranch_scc1 L_h_rejoin0
    ds_read2st64_b32 v[52:53], v167 offset0:36 offset1:37
    ds_read2st64_b32 v[54:55], v167 offset0:38 offset1:39
    s_waitcnt lgkmcnt(0)
    v_smfmac_f32_16x16x64_bf16 v[16:19], v[52:55], v[132:139], v2
    v_smfmac_f32_16x16x64_bf16 v[20:23], v[52:55], v[100:107], v2
    v_smfmac_f32_16x16x64_bf16 v[24:27], v[52:55], v[108:115], v2
    v_smfmac_f32_16x16x64_bf16 v[28:31], v[52:55], v[156:163], v2
    v_smfmac_f32_16x16x64_bf16 v[32:35], v[52:55], v[140:147], v2
    v_smfmac_f32_16x16x64_bf16 v[36:39], v[52:55], v[148:155], v2
    v_smfmac_f32_16x16x64_bf16 v[40:43], v[52:55], v[116:123], v2
    v_smfmac_f32_16x16x64_bf16 v[44:47], v[52:55], v[124:131], v2
    s_add_u32 s86, s86, 1
    s_xor_b32 s85, s86, s67
    s_add_u32 s85, s85, s66
    s_and_b32 s85, s85, 7
    s_lshl_b32 s85, s85, 16
    s_add_u32 s85, s85, s57
    s_branch L_h_ex0
L_h_qx11:
    s_mov_b32 s78, 20000
L_h_qa11:
    s_sub_u32 s78, s78, 1
    s_cmp_lt_i32 s78, 0
    s_cbranch_scc1 L_h_qb11
    s_sleep 6
    buffer_load_dwordx4 v[156:159], v4, s[36:39], s69 offen offset:256 sc1
    s_waitcnt vmcnt(0)
    v_cmp_eq_u32 vcc, -1, v156
    s_cbranch_vccnz L_h_qa11
    s_branch L_h_qb11
L_h_qx12:
    s_mov_b32 s78, 20000
L_h_qa12:
    s_sub_u32 s78, s78, 1
    s_cmp_lt_i32 s78, 0
    s_cbranch_scc1 L_h_qb12
    s_sleep 6
    buffer_load_dwordx4 v[156:159], v4, s[36:39], s69 offen offset:512 sc1
    s_waitcnt vmcnt(0)
    v_cmp_eq_u32 vcc, -1, v156
    s_cbranch_vccnz L_h_qa12
    s_branch L_h_qb12
L_h_qx13:
    s_mov_b32 s78, 20000
L_h_qa13:
    s_sub_u32 s78, s78, 1
    s_cmp_lt_i32 s78, 0
    s_cbranch_scc1 L_h_qb13
    s_sleep 6
    buffer_load_dwordx4 v[156:159], v4, s[36:39], s69 offen offset:768 sc1
    s_waitcnt vmcnt(0)
    v_cmp_eq_u32 vcc, -1, v156
    s_cbranch_vccnz L_h_qa13
    s_branch L_h_qb13
L_h_exact1:
    s_waitcnt vmcnt(0) lgkmcnt(0)
    v_mov_b64 v[16:17], 0
    v_mov_b64 v[18:19], 0
    v_mov_b64 v[20:21], 0
    v_mov_b64 v[22:23], 0
    v_mov_b64 v[24:25], 0
    v_mov_b64 v[26:27], 0
    v_mov_b64 v[28:29], 0
    v_mov_b64 v[30:31], 0
    v_mov_b64 v[32:33], 0
    v_mov_b64 v[34:35], 0
    v_mov_b64 v[36:37], 0
    v_mov_b64 v[38:39], 0
    v_mov_b64 v[40:41], 0
    v_mov_b64 v[42:43], 0
    v_mov_b64 v[44:45], 0
    v_mov_b64 v[46:47], 0
    s_mov_b32 s85, s8
    s_mov_b32 s86, 0
L_h_ex1:
    s_add_u32 s6, s85, 1572864
    buffer_load_dwordx4 v[140:143], v4, s[36:39], s6 offen sc1
    buffer_load_dwordx4 v[144:147], v4, s[36:39], s6 offen offset:1024 sc1
    s_add_u32 s6, s85, 1574912
    buffer_load_dwordx4 v[148:151], v4, s[36:39], s6 offen sc1
    buffer_load_dwordx4 v[152:155], v4, s[36:39], s6 offen offset:1024 sc1
    s_add_u32 s6, s85, 1576960
    buffer_load_dwordx4 v[116:119], v4, s[36:39], s6 offen sc1
    buffer_load_dwordx4 v[120:123], v4, s[36:39], s6 offen offset:1024 sc1
    s_add_u32 s6, s85, 1579008
    buffer_load_dwordx4 v[156:159], v4, s[36:39], s6 offen sc1
    buffer_load_dwordx4 v[160:163], v4, s[36:39], s6 offen offset:1024 sc1
    s_add_u32 s6, s85, 1581056
    buffer_load_dwordx4 v[124:127], v4, s[36:39], s6 offen sc1
    buffer_load_dwordx4 v[128:131], v4, s[36:39], s6 offen offset:1024 sc1
    s_add_u32 s6, s85, 1583104
    buffer_load_dwordx4 v[84:87], v4, s[36:39], s6 offen sc1
    buffer_load_dwordx4 v[88:91], v4, s[36:39], s6 offen offset:1024 sc1
    s_add_u32 s6, s85, 1585152
    buffer_load_dwordx4 v[92:95], v4, s[36:39], s6 offen sc1
    buffer_load_dwordx4 v[96:99], v4, s[36:39], s6 offen offset:1024 sc1
    s_add_u32 s6, s85, 1587200
    buffer_load_dwordx4 v[132:135], v4, s[36:39], s6 offen sc1
    buffer_load_dwordx4 v[136:139], v4, s[36:39], s6 offen offset:1024 sc1
    s_barrier
    s_barrier
    ds_read_b128 v[76:79], v4 offset:10240
    ds_read_b64 v[60:61], v5 offset:0
    ds_read_b64 v[62:63], v5 offset:2048
    ds_read_b64 v[64:65], v5 offset:4096
    ds_read_b64 v[66:67], v5 offset:6144
    ds_read_b64 v[68:69], v5 offset:8192
    ds_read_b64 v[70:71], v5 offset:10240
    ds_read_b64 v[72:73], v5 offset:12288
    ds_read_b64 v[74:75], v5 offset:14336
    s_waitcnt lgkmcnt(8)
    v_add_f32 v76, v76, v77
    v_add_f32 v78, v78, v79
    v_add_f32 v77, v76, v78
    v_add_f32 v76, v76, v78
    s_nop 1
    v_permlane32_swap_b32 v76, v77
    v_add_f32 v76, v76, v77
    v_rcp_f32 v78, v76
    s_nop 0
    v_max3_f32 v9, v9, v76, v78
    s_waitcnt lgkmcnt(0)
    v_add_f32 v60, v60, v62
    v_add_f32 v61, v61, v63
    v_add_f32 v60, v60, v64
    v_add_f32 v61, v61, v65
    v_add_f32 v60, v60, v66
    v_add_f32 v61, v61, v67
    v_add_f32 v60, v60, v68
    v_add_f32 v61, v61, v69
    v_add_f32 v60, v60, v70
    v_add_f32 v61, v61, v71
    v_add_f32 v60, v60, v72
    v_add_f32 v61, v61, v73
    v_add_f32 v60, v60, v74
    v_add_f32 v61, v61, v75
    v_mul_f32 v60, v60, v78
    v_mul_f32 v61, v61, v78
    v_cvt_pk_bf16_f32 v60, v60, v61
    ds_write_b32 v7, v60 offset:9216
    s_waitcnt vmcnt(0) lgkmcnt(0)
    s_barrier
    s_cmp_eq_u32 s86, 7
    s_cbranch_scc1 L_h_rejoin1
    ds_read2st64_b32 v[52:53], v167 offset0:36 offset1:37
    ds_read2st64_b32 v[54:55], v167 offset0:38 offset1:39
    s_waitcnt lgkmcnt(0)
    v_smfmac_f32_16x16x64_bf16 v[16:19], v[52:55], v[140:147], v2
    v_smfmac_f32_16x16x64_bf16 v[20:23], v[52:55], v[148:155], v2
    v_smfmac_f32_16x16x64_bf16 v[24:27], v[52:55], v[116:123], v2
    v_smfmac_f32_16x16x64_bf16 v[28:31], v[52:55], v[156:163], v2
    v_smfmac_f32_16x16x64_bf16 v[32:35], v[52:55], v[124:131], v2
    v_smfmac_f32_16x16x64_bf16 v[36:39], v[52:55], v[84:91], v2
    v_smfmac_f32_16x16x64_bf16 v[40:43], v[52:55], v[92:99], v2
    v_smfmac_f32_16x16x64_bf16 v[44:47], v[52:55], v[132:139], v2
    s_add_u32 s86, s86, 1
    s_xor_b32 s85, s86, s67
    s_add_u32 s85, s85, s66
    s_and_b32 s85, s85, 7
    s_lshl_b32 s85, s85, 16
    s_add_u32 s85, s85, s57
    s_branch L_h_ex1
L_exit:
    s_endpgm
.section .rodata,"a"
.p2align 6
.amdhsa_kernel interleave_layers__grouped_kv_mqa__ssm_conv_h3__prompt_kernel
  .amdhsa_next_free_vgpr 168
  .amdhsa_next_free_sgpr 96
  .amdhsa_accum_offset 168
  .amdhsa_group_segment_fixed_size 0
  .amdhsa_kernarg_size 112
  .amdhsa_user_sgpr_count 2
  .amdhsa_user_sgpr_kernarg_segment_ptr 1
  .amdhsa_system_sgpr_workgroup_id_x 1
.end_amdhsa_kernel
```
